```python
import torch

def _softmax(x, axis=-1):
    return torch.softmax(x, dim=axis)
def _gelu(x):
    return torch.nn.functional.gelu(x, approximate="tanh")
def _silu(x):
    return torch.nn.functional.silu(x)
def _sigmoid(x):
    return torch.sigmoid(x)
def _layernorm(x, axis=-1, eps=1e-5):
    m = x.mean(dim=axis, keepdim=True)
    v = x.var(dim=axis, keepdim=True, unbiased=False)
    return (x - m) / torch.sqrt(v + eps)
def _scatter_add(tgt, idx, src, axis=0):
    return tgt.clone().index_add_(axis, idx, src)
def _segment_sum(src, seg, n):
    out = torch.zeros((n,) + src.shape[1:], dtype=src.dtype)
    return out.index_add_(0, seg, src)
def _pad(x, pw):
    flat = tuple(v for pair in reversed(pw) for v in pair)
    return torch.nn.functional.pad(x, flat)

kernel_name = 'sequential_preLN__gqa_block_cached__dense_activation_squared_relu__decode'

def setup_inputs():

    _w = (lambda a: (lambda t: t.to(torch.bfloat16) if t.is_floating_point() else t)(torch.as_tensor(a)))
    def _A_setup():
        B, Sq, D = 1, 1, 576
        Hq, Hkv, Sk, Dh = 32, 16, 65536, 128
        assert Hq % Hkv == 0, (Hq, Hkv)
        return {
            "x": _w((lambda *s: torch.randn(*s, dtype=torch.bfloat16) * 0.05)(B, Sq, D)),
            "k_cache": _w((lambda *s: torch.randn(*s, dtype=torch.bfloat16) * 3.2)(B, Hkv, Sk, Dh)),
            "v_cache": _w((lambda *s: torch.randn(*s, dtype=torch.bfloat16) * 0.4)(B, Hkv, Sk, Dh)),
            "wq": _w((lambda *s: torch.randn(*s, dtype=torch.bfloat16) * 3.2)(D, Hq * Dh) * (D ** -0.5)),
            "wo": _w((lambda *s: torch.randn(*s, dtype=torch.bfloat16) * 0.4)(Hq * Dh, D) * ((Hq * Dh) ** -0.5)),
        }
    _A_in = _A_setup()

    def _B_setup():
        B, S, D, F = 1, 1, 576, 4608
        return {
            "x": _w((lambda *s: torch.randn(*s, dtype=torch.bfloat16) * 0.05)(B, S, D)),
            "w1": _w((lambda *s: torch.randn(*s, dtype=torch.bfloat16) * 0.05)(D, F)),
            "b1": _w((lambda *s: torch.randn(*s, dtype=torch.bfloat16) * 0.05)(F)),
            "w2": _w((lambda *s: torch.randn(*s, dtype=torch.bfloat16) * 0.05)(F, D)),
            "b2": _w((lambda *s: torch.randn(*s, dtype=torch.bfloat16) * 0.05)(D)),
        }
    _B_in = _B_setup()

    return {
        "A_x": _A_in["x"],
        "A_k_cache": _A_in["k_cache"],
        "A_v_cache": _A_in["v_cache"],
        "A_wq": _A_in["wq"],
        "A_wo": _A_in["wo"],
        "B_x": _B_in["x"],
        "B_w1": _B_in["w1"],
        "B_b1": _B_in["b1"],
        "B_w2": _B_in["w2"],
        "B_b2": _B_in["b2"],
    }

def reference(A_x, A_k_cache, A_v_cache, A_wq, A_wo, B_x, B_w1, B_b1, B_w2, B_b2):
    def _A_ref(x, k_cache, v_cache, wq, wo):
        B, Sq, D = x.shape
        Hq, Dh = 32, 128
        Hkv = k_cache.shape[1]
        rep = Hq // Hkv
        q = (lambda x, *d: x.permute(*d))((x @ wq).reshape(B, Sq, Hq, Dh), 0, 2, 1, 3)
        k = (lambda x, n, axis: torch.repeat_interleave(x, n, dim=axis))(k_cache, rep, axis=1)
        v = (lambda x, n, axis: torch.repeat_interleave(x, n, dim=axis))(v_cache, rep, axis=1)
        scores = torch.einsum("bhqd,bhkd->bhqk", q, k) * (Dh ** -0.5)
        p = _softmax(scores, axis=-1)
        o = torch.einsum("bhqk,bhkd->bhqd", p, v)
        return (lambda x, *d: x.permute(*d))(o, 0, 2, 1, 3).reshape(B, Sq, Hq * Dh) @ wo

    def _B_ref(x, w1, b1, w2, b2):
        h = torch.einsum("bsd,df->bsf", x, w1) + b1
        zero = torch.zeros_like(h)
        r = torch.where(h > zero, h, zero)
        h = r * r
        out = torch.einsum("bsf,fd->bsd", h, w2) + b2
        return out

    x = A_x
    h = x + _A_ref(_layernorm(x, axis=-1), A_k_cache, A_v_cache, A_wq, A_wo)
    h2 = h + _B_ref(_layernorm(h, axis=-1), B_w1, B_b1, B_w2, B_b2)
    return h2
```

```asm
; @launch kernel=fused_kernel grid=(256,1,1) block=(576,1,1) lds=87552
.amdgcn_target "amdgcn-amd-amdhsa--gfx950"
.text
.globl fused_kernel
.p2align 8
.type fused_kernel,@function
fused_kernel:
    s_load_dwordx16 s[40:55], s[0:1], 0
    s_load_dwordx8 s[56:63], s[0:1], 64
    s_load_dwordx2 s[64:65], s[0:1], 96
    s_cmp_ge_u32 s2, 256
    s_cbranch_scc1 K_end
    s_mov_b32 s3, 0
    s_bitcmp1_b32 s2, 0
    s_cselect_b32 s4, 1, 0
    s_xor_b32 s3, s3, s4
    s_bitcmp1_b32 s2, 1
    s_cselect_b32 s4, 8, 0
    s_xor_b32 s3, s3, s4
    s_bitcmp1_b32 s2, 2
    s_cselect_b32 s4, 4, 0
    s_xor_b32 s3, s3, s4
    s_bitcmp1_b32 s2, 3
    s_cselect_b32 s4, 2, 0
    s_xor_b32 s3, s3, s4
    s_bitcmp1_b32 s2, 4
    s_cselect_b32 s4, 17, 0
    s_xor_b32 s3, s3, s4
    s_bitcmp1_b32 s2, 5
    s_cselect_b32 s4, 40, 0
    s_xor_b32 s3, s3, s4
    s_bitcmp1_b32 s2, 6
    s_cselect_b32 s4, 68, 0
    s_xor_b32 s3, s3, s4
    s_bitcmp1_b32 s2, 7
    s_cselect_b32 s4, 128, 0
    s_xor_b32 s3, s3, s4
    s_mov_b32 s2, s3
    v_and_b32 v1, 63, v0
    v_lshrrev_b32 v39, 6, v0
    v_lshlrev_b32 v38, 4, v1
    v_readfirstlane_b32 s26, v39
    s_mov_b32 s29, 1035273459
    s_mov_b32 s30, 1069066811
    s_lshr_b32 s24, s2, 4
    s_and_b32 s25, s2, 15
    s_and_b32 s3, s2, 7
    s_lshr_b32 s4, s2, 3
    s_lshl_b32 s28, s3, 5
    s_add_u32 s28, s28, s4
    s_lshl_b32 s10, s24, 24
    s_lshl_b32 s27, s25, 20
    s_add_u32 s27, s27, s10
    v_mov_b32 v160, 61184
    v_mov_b32 v40, 12
    v_mov_b32 v41, 0
    v_mov_b32 v44, -1
    v_mov_b32 v45, -1
    v_mov_b32 v46, -1
    v_mov_b32 v47, -1
    v_lshlrev_b32 v42, 4, v0
    v_add_u32 v42, 0, v42
    ds_write_b32 v160, v40
    ds_write_b32 v160, v41 offset:16
    ds_write_b32 v160, v41 offset:24
    ds_write_b32 v160, v41 offset:28
    ds_write_b32 v160, v41 offset:32
    ds_write_b128 v42, v[44:47]
    ds_write_b128 v42, v[44:47] offset:9216
    ds_write_b128 v42, v[44:47] offset:18432
    v_lshlrev_b32 v42, 2, v0
    v_add_u32 v42, 82944, v42
    ds_write_b32 v42, v44
    v_cmp_gt_u32 vcc, 36, v0
    v_cndmask_b32 v43, 0, v44, vcc
    ds_write_b32 v42, v43 offset:2304
    s_waitcnt lgkmcnt(0)
    s_barrier
    s_mov_b32 s12, s42
    s_mov_b32 s13, s43
    s_mov_b32 s14, 268435456
    s_mov_b32 s15, 0x00020000
    s_mov_b32 s16, s44
    s_mov_b32 s17, s45
    s_mov_b32 s18, 268435456
    s_mov_b32 s19, 0x00020000
    s_mov_b32 s20, s64
    s_mov_b32 s21, s65
    s_mov_b32 s22, 1073741824
    s_mov_b32 s23, 0x00020000
    s_mov_b32 s68, s40
    s_mov_b32 s69, s41
    s_mov_b32 s70, 1152
    s_mov_b32 s71, 0x00020000
    s_mov_b32 s72, s46
    s_mov_b32 s73, s47
    s_mov_b32 s74, 4718592
    s_mov_b32 s75, 0x00020000
    s_mov_b32 s76, s48
    s_mov_b32 s77, s49
    s_mov_b32 s78, 4718592
    s_mov_b32 s79, 0x00020000
    s_mov_b32 s80, s52
    s_mov_b32 s81, s53
    s_mov_b32 s82, 5308416
    s_mov_b32 s83, 0x00020000
    s_mov_b32 s84, s56
    s_mov_b32 s85, s57
    s_mov_b32 s86, 5308416
    s_mov_b32 s87, 0x00020000
    s_mov_b32 s88, s54
    s_mov_b32 s89, s55
    s_mov_b32 s90, 9216
    s_mov_b32 s91, 0x00020000
    s_mov_b32 s92, s58
    s_mov_b32 s93, s59
    s_mov_b32 s94, 1152
    s_mov_b32 s95, 0x00020000
    s_mov_b32 s96, s60
    s_mov_b32 s97, s61
    s_mov_b32 s98, 1152
    s_mov_b32 s99, 0x00020000
    s_mov_b32 s4, s62
    s_mov_b32 s5, s63
    s_mov_b32 s6, 256
    s_mov_b32 s7, 0x00020000
    s_cmp_lt_u32 s26, 4
    s_cbranch_scc1 K_lop
    s_setprio 3
K_lop:
    s_cmp_eq_u32 s26, 4
    s_cbranch_scc1 K_helper
    s_cmp_gt_u32 s26, 4
    s_cbranch_scc1 K_wts
    s_mov_b64 s[60:61], s[12:13]
    s_mov_b64 s[62:63], s[14:15]
    s_mov_b64 s[52:53], s[12:13]
    s_mov_b64 s[54:55], s[14:15]
    s_mov_b32 s58, 0x11111111
    s_mov_b32 s59, 0x11111111
    s_mov_b32 s0, 0xaaaaaaaa
    s_mov_b32 s1, 0xaaaaaaaa
    s_mov_b32 s50, 0x33333333
    s_mov_b32 s51, 0x33333333
    v_lshlrev_b32 v162, 1, v1
    s_mov_b32 s47, 0
    s_mov_b32 s44, -1
    s_mov_b32 s45, 1
    s_mov_b32 s32, 0
    s_lshl_b32 s37, s26, 7
    s_add_u32 s40, s37, 0
    s_mov_b32 s33, 0
    s_lshl_b32 s37, s26, 7
    s_add_u32 s41, s37, 512
    s_sleep 28
    s_add_u32 s37, s26, 0
    s_lshl_b32 s38, s37, 13
    s_add_u32 s56, s38, s27
    s_add_u32 s57, s56, 4096
    buffer_load_dwordx4 v[64:67], v38, s[60:63], s56 offen offset:0 nt
    buffer_load_dwordx4 v[68:71], v38, s[60:63], s56 offen offset:1024 nt
    buffer_load_dwordx4 v[72:75], v38, s[60:63], s56 offen offset:2048 nt
    buffer_load_dwordx4 v[76:79], v38, s[60:63], s56 offen offset:3072 nt
    ds_read_b32 v40, v160 offset:16
    s_waitcnt lgkmcnt(0)
    v_readfirstlane_b32 s36, v40
    s_nop 3
    s_cmp_lg_u32 s36, 0
    s_cbranch_scc1 K_pw0
    s_waitcnt vmcnt(0)
K_pw0:
    buffer_load_dwordx4 v[80:83], v38, s[52:55], s57 offen offset:0 nt
    buffer_load_dwordx4 v[84:87], v38, s[52:55], s57 offen offset:1024 nt
    buffer_load_dwordx4 v[88:91], v38, s[52:55], s57 offen offset:2048 nt
    buffer_load_dwordx4 v[92:95], v38, s[52:55], s57 offen offset:3072 nt
    ds_read_b32 v40, v160 offset:16
    s_waitcnt lgkmcnt(0)
    v_readfirstlane_b32 s36, v40
    s_nop 3
    s_cmp_lg_u32 s36, 0
    s_cbranch_scc1 K_pw1
    s_waitcnt vmcnt(0)
K_pw1:
    s_add_u32 s37, s26, 4
    s_lshl_b32 s38, s37, 13
    s_add_u32 s56, s38, s27
    s_add_u32 s57, s56, 4096
    buffer_load_dwordx4 v[96:99], v38, s[60:63], s56 offen offset:0 nt
    buffer_load_dwordx4 v[100:103], v38, s[60:63], s56 offen offset:1024 nt
    buffer_load_dwordx4 v[104:107], v38, s[60:63], s56 offen offset:2048 nt
    buffer_load_dwordx4 v[108:111], v38, s[60:63], s56 offen offset:3072 nt
    ds_read_b32 v40, v160 offset:16
    s_waitcnt lgkmcnt(0)
    v_readfirstlane_b32 s36, v40
    s_nop 3
    s_cmp_lg_u32 s36, 0
    s_cbranch_scc1 K_pw2
    s_waitcnt vmcnt(0)
K_pw2:
    buffer_load_dwordx4 v[112:115], v38, s[52:55], s57 offen offset:0 nt
    buffer_load_dwordx4 v[116:119], v38, s[52:55], s57 offen offset:1024 nt
    buffer_load_dwordx4 v[120:123], v38, s[52:55], s57 offen offset:2048 nt
    buffer_load_dwordx4 v[124:127], v38, s[52:55], s57 offen offset:3072 nt
    s_add_u32 s37, s26, 8
    s_lshl_b32 s38, s37, 13
    s_add_u32 s56, s38, s27
    s_add_u32 s57, s56, 4096
    s_lshl_b32 s37, s26, 7
    s_add_u32 s48, s37, 1024
K_wq:
    ds_read_b32 v40, v160 offset:16
    s_waitcnt lgkmcnt(0)
    v_readfirstlane_b32 s36, v40
    s_nop 3
    s_cmp_lg_u32 s36, 0
    s_cbranch_scc1 K_wqok
    s_sleep 1
    s_branch K_wq
K_wqok:
    v_and_b32 v40, 15, v1
    v_lshlrev_b32 v40, 4, v40
    v_add_u32 v40, 60672, v40
    ds_read_b128 v[2:5], v40
    ds_read_b128 v[6:9], v40 offset:256
    v_mov_b32 v10, 0xff800000
    v_mov_b32 v11, 0
    s_mov_b32 s66, 0
    s_mov_b32 s67, 0
    s_mov_b32 s65, 0
    v_mov_b32 v14, 0
    v_mov_b32 v15, 0
    v_mov_b32 v16, 0
    v_mov_b32 v17, 0
    v_mov_b32 v18, 0
    v_mov_b32 v19, 0
    v_mov_b32 v20, 0
    v_mov_b32 v21, 0
    v_mov_b32 v22, 0
    v_mov_b32 v23, 0
    v_mov_b32 v24, 0
    v_mov_b32 v25, 0
    v_mov_b32 v26, 0
    v_mov_b32 v27, 0
    v_mov_b32 v28, 0
    v_mov_b32 v29, 0
    s_waitcnt lgkmcnt(0)
K_loop:
    s_cmp_lg_u32 s32, 0
    s_cbranch_scc1 VL_0
KL_0:
    s_cmp_eq_u32 s45, 0
    s_cbranch_scc1 CL_1
    v_mov_b32 v161, 1
    s_mov_b64 exec, 1
    ds_add_rtn_u32 v161, v160, v161
    s_mov_b64 exec, -1
CL_1:
    s_waitcnt vmcnt(14)
    v_dot2_f32_bf16 v40, v64, v2, 0
    v_dot2_f32_bf16 v41, v64, v6, 0
    v_dot2_f32_bf16 v42, v68, v2, 0
    v_dot2_f32_bf16 v43, v68, v6, 0
    v_dot2c_f32_bf16 v40, v65, v3
    v_dot2c_f32_bf16 v41, v65, v7
    v_dot2c_f32_bf16 v42, v69, v3
    v_dot2c_f32_bf16 v43, v69, v7
    v_dot2c_f32_bf16 v40, v66, v4
    v_dot2c_f32_bf16 v41, v66, v8
    v_dot2c_f32_bf16 v42, v70, v4
    v_dot2c_f32_bf16 v43, v70, v8
    v_dot2c_f32_bf16 v40, v67, v5
    v_dot2c_f32_bf16 v41, v67, v9
    v_dot2c_f32_bf16 v42, v71, v5
    v_dot2c_f32_bf16 v43, v71, v9
    buffer_load_dwordx4 v[64:67], v38, s[60:63], s56 offen offset:0 nt
    buffer_load_dwordx4 v[68:71], v38, s[60:63], s56 offen offset:1024 nt
    s_waitcnt vmcnt(14)
    v_dot2_f32_bf16 v44, v72, v2, 0
    v_dot2_f32_bf16 v45, v72, v6, 0
    v_dot2_f32_bf16 v46, v76, v2, 0
    v_dot2_f32_bf16 v47, v76, v6, 0
    v_dot2c_f32_bf16 v44, v73, v3
    v_dot2c_f32_bf16 v45, v73, v7
    v_dot2c_f32_bf16 v46, v77, v3
    v_dot2c_f32_bf16 v47, v77, v7
    v_dot2c_f32_bf16 v44, v74, v4
    v_dot2c_f32_bf16 v45, v74, v8
    v_dot2c_f32_bf16 v46, v78, v4
    v_dot2c_f32_bf16 v47, v78, v8
    v_dot2c_f32_bf16 v44, v75, v5
    v_dot2c_f32_bf16 v45, v75, v9
    v_dot2c_f32_bf16 v46, v79, v5
    v_dot2c_f32_bf16 v47, v79, v9
    buffer_load_dwordx4 v[72:75], v38, s[60:63], s56 offen offset:2048 nt
    buffer_load_dwordx4 v[76:79], v38, s[60:63], s56 offen offset:3072 nt
    s_waitcnt vmcnt(14)
    v_dot2_f32_bf16 v48, v80, v2, 0
    v_dot2_f32_bf16 v49, v80, v6, 0
    v_dot2_f32_bf16 v50, v84, v2, 0
    v_dot2_f32_bf16 v51, v84, v6, 0
    v_dot2c_f32_bf16 v48, v81, v3
    v_dot2c_f32_bf16 v49, v81, v7
    v_dot2c_f32_bf16 v50, v85, v3
    v_dot2c_f32_bf16 v51, v85, v7
    v_dot2c_f32_bf16 v48, v82, v4
    v_dot2c_f32_bf16 v49, v82, v8
    v_dot2c_f32_bf16 v50, v86, v4
    v_dot2c_f32_bf16 v51, v86, v8
    v_dot2c_f32_bf16 v48, v83, v5
    v_dot2c_f32_bf16 v49, v83, v9
    v_dot2c_f32_bf16 v50, v87, v5
    v_dot2c_f32_bf16 v51, v87, v9
    buffer_load_dwordx4 v[80:83], v38, s[52:55], s57 offen offset:0 nt
    buffer_load_dwordx4 v[84:87], v38, s[52:55], s57 offen offset:1024 nt
    s_waitcnt vmcnt(14)
    v_dot2_f32_bf16 v52, v88, v2, 0
    v_dot2_f32_bf16 v53, v88, v6, 0
    v_dot2_f32_bf16 v54, v92, v2, 0
    v_dot2_f32_bf16 v55, v92, v6, 0
    v_dot2c_f32_bf16 v52, v89, v3
    v_dot2c_f32_bf16 v53, v89, v7
    v_dot2c_f32_bf16 v54, v93, v3
    v_dot2c_f32_bf16 v55, v93, v7
    v_dot2c_f32_bf16 v52, v90, v4
    v_dot2c_f32_bf16 v53, v90, v8
    v_dot2c_f32_bf16 v54, v94, v4
    v_dot2c_f32_bf16 v55, v94, v8
    v_dot2c_f32_bf16 v52, v91, v5
    v_dot2c_f32_bf16 v53, v91, v9
    v_dot2c_f32_bf16 v54, v95, v5
    v_dot2c_f32_bf16 v55, v95, v9
    buffer_load_dwordx4 v[88:91], v38, s[52:55], s57 offen offset:2048 nt
    buffer_load_dwordx4 v[92:95], v38, s[52:55], s57 offen offset:3072 nt
    v_add_f32_dpp v40, v40, v40 row_ror:8 row_mask:0xf bank_mask:0x3
    v_add_f32_dpp v40, v48, v48 row_ror:8 row_mask:0xf bank_mask:0xc
    v_add_f32_dpp v41, v41, v41 row_ror:8 row_mask:0xf bank_mask:0x3
    v_add_f32_dpp v41, v49, v49 row_ror:8 row_mask:0xf bank_mask:0xc
    v_add_f32_dpp v42, v42, v42 row_ror:8 row_mask:0xf bank_mask:0x3
    v_add_f32_dpp v42, v50, v50 row_ror:8 row_mask:0xf bank_mask:0xc
    v_add_f32_dpp v43, v43, v43 row_ror:8 row_mask:0xf bank_mask:0x3
    v_add_f32_dpp v43, v51, v51 row_ror:8 row_mask:0xf bank_mask:0xc
    v_add_f32_dpp v44, v44, v44 row_ror:8 row_mask:0xf bank_mask:0x3
    v_add_f32_dpp v44, v52, v52 row_ror:8 row_mask:0xf bank_mask:0xc
    v_add_f32_dpp v45, v45, v45 row_ror:8 row_mask:0xf bank_mask:0x3
    v_add_f32_dpp v45, v53, v53 row_ror:8 row_mask:0xf bank_mask:0xc
    v_add_f32_dpp v46, v46, v46 row_ror:8 row_mask:0xf bank_mask:0x3
    v_add_f32_dpp v46, v54, v54 row_ror:8 row_mask:0xf bank_mask:0xc
    v_add_f32_dpp v47, v47, v47 row_ror:8 row_mask:0xf bank_mask:0x3
    v_add_f32_dpp v47, v55, v55 row_ror:8 row_mask:0xf bank_mask:0xc
    v_add_f32_dpp v40, v40, v40 row_half_mirror row_mask:0xf bank_mask:0x5
    v_add_f32_dpp v40, v44, v44 row_half_mirror row_mask:0xf bank_mask:0xa
    v_add_f32_dpp v41, v41, v41 row_half_mirror row_mask:0xf bank_mask:0x5
    v_add_f32_dpp v41, v45, v45 row_half_mirror row_mask:0xf bank_mask:0xa
    v_add_f32_dpp v42, v42, v42 row_half_mirror row_mask:0xf bank_mask:0x5
    v_add_f32_dpp v42, v46, v46 row_half_mirror row_mask:0xf bank_mask:0xa
    v_add_f32_dpp v43, v43, v43 row_half_mirror row_mask:0xf bank_mask:0x5
    v_add_f32_dpp v43, v47, v47 row_half_mirror row_mask:0xf bank_mask:0xa
    v_add_f32_dpp v40, v40, v40 quad_perm:[1,0,3,2] row_mask:0xf bank_mask:0xf
    v_add_f32_dpp v41, v41, v41 quad_perm:[1,0,3,2] row_mask:0xf bank_mask:0xf
    v_add_f32_dpp v42, v42, v42 quad_perm:[1,0,3,2] row_mask:0xf bank_mask:0xf
    v_add_f32_dpp v43, v43, v43 quad_perm:[1,0,3,2] row_mask:0xf bank_mask:0xf
    v_add_f32_dpp v40, v40, v40 quad_perm:[2,3,0,1] row_mask:0xf bank_mask:0xf
    v_add_f32_dpp v41, v41, v41 quad_perm:[2,3,0,1] row_mask:0xf bank_mask:0xf
    v_add_f32_dpp v42, v42, v42 quad_perm:[2,3,0,1] row_mask:0xf bank_mask:0xf
    v_add_f32_dpp v43, v43, v43 quad_perm:[2,3,0,1] row_mask:0xf bank_mask:0xf
    v_cvt_pk_bf16_f32 v30, v40, v41
    v_cvt_pk_bf16_f32 v31, v42, v43
    v_add_u32 v13, s40, v162
    v_lshlrev_b32 v40, 16, v30
    v_and_b32 v41, 0xffff0000, v30
    v_lshlrev_b32 v42, 16, v31
    v_and_b32 v43, 0xffff0000, v31
    v_mul_f32 v40, s29, v40
    v_mul_f32 v41, s29, v41
    v_mul_f32 v42, s29, v42
    v_mul_f32 v43, s29, v43
    v_cvt_pk_bf16_f32 v56, v40, v41
    v_cvt_pk_bf16_f32 v57, v42, v43
    s_mov_b64 exec, s[58:59]
    ds_write_b64 v13, v[56:57]
    s_mov_b64 exec, -1
    s_mov_b32 s32, s47
    s_mov_b32 s40, s48
    s_waitcnt lgkmcnt(0)
    s_mov_b32 s37, 2147483647
    s_cmp_eq_u32 s45, 0
    s_cbranch_scc1 RG_k0
    v_readfirstlane_b32 s36, v161
    s_nop 3
    s_cmp_ge_u32 s36, 224
    s_cbranch_scc1 RP_k0
    s_sub_u32 s38, s36, 112
    s_cmp_lt_u32 s36, 112
    s_cselect_b32 s37, s36, s38
    s_cselect_b32 s47, 0, 1
    s_cselect_b64 s[60:61], s[12:13], s[16:17]
    s_cselect_b64 s[52:53], s[12:13], s[16:17]
    s_lshl_b32 s38, s37, 13
    s_add_u32 s56, s38, s27
    s_add_u32 s57, s56, 4096
    s_lshl_b32 s38, s37, 7
    s_add_u32 s48, s38, 0
    s_branch RD_k0
RP_k0:
    s_lshl_b32 s36, s36, 2
    s_add_u32 s36, s36, 15488
    s_mov_b32 s39, 0
    s_mov_b64 s[60:61], s[12:13]
    s_mov_b64 s[52:53], s[16:17]
RQ_k0:
    v_mov_b32 v161, s36
    ds_read_b32 v161, v161
    s_add_u32 s39, s39, 1
    s_waitcnt lgkmcnt(0)
    v_readfirstlane_b32 s37, v161
    s_nop 3
    s_cmp_lg_u32 s37, -1
    s_cbranch_scc1 RG_k0
    s_cmp_ge_u32 s39, 2097152
    s_cbranch_scc1 RG_k0
    s_sleep 1
    s_branch RQ_k0
RG_k0:
    s_and_b32 s38, s37, 15
    s_lshr_b32 s39, s37, 4
    s_lshl_b32 s38, s38, 20
    s_lshl_b32 s39, s39, 12
    s_add_u32 s38, s38, s39
    s_add_u32 s38, s38, s10
    s_add_u32 s38, s38, 917504
    s_cmp_lt_u32 s37, 512
    s_cselect_b32 s56, s38, 2147418112
    s_cselect_b32 s47, 2, 3
    s_cselect_b32 s45, s45, 0
    s_xor_b32 s57, s56, 0
RD_k0:
    s_cmp_lg_u32 s33, 0
    s_cbranch_scc1 VL_1
KL_1:
    s_cmp_eq_u32 s45, 0
    s_cbranch_scc1 CL_2
    v_mov_b32 v161, 1
    s_mov_b64 exec, 1
    ds_add_rtn_u32 v161, v160, v161
    s_mov_b64 exec, -1
CL_2:
    s_waitcnt vmcnt(14)
    v_dot2_f32_bf16 v40, v96, v2, 0
    v_dot2_f32_bf16 v41, v96, v6, 0
    v_dot2_f32_bf16 v42, v100, v2, 0
    v_dot2_f32_bf16 v43, v100, v6, 0
    v_dot2c_f32_bf16 v40, v97, v3
    v_dot2c_f32_bf16 v41, v97, v7
    v_dot2c_f32_bf16 v42, v101, v3
    v_dot2c_f32_bf16 v43, v101, v7
    v_dot2c_f32_bf16 v40, v98, v4
    v_dot2c_f32_bf16 v41, v98, v8
    v_dot2c_f32_bf16 v42, v102, v4
    v_dot2c_f32_bf16 v43, v102, v8
    v_dot2c_f32_bf16 v40, v99, v5
    v_dot2c_f32_bf16 v41, v99, v9
    v_dot2c_f32_bf16 v42, v103, v5
    v_dot2c_f32_bf16 v43, v103, v9
    buffer_load_dwordx4 v[96:99], v38, s[60:63], s56 offen offset:0 nt
    buffer_load_dwordx4 v[100:103], v38, s[60:63], s56 offen offset:1024 nt
    s_waitcnt vmcnt(14)
    v_dot2_f32_bf16 v44, v104, v2, 0
    v_dot2_f32_bf16 v45, v104, v6, 0
    v_dot2_f32_bf16 v46, v108, v2, 0
    v_dot2_f32_bf16 v47, v108, v6, 0
    v_dot2c_f32_bf16 v44, v105, v3
    v_dot2c_f32_bf16 v45, v105, v7
    v_dot2c_f32_bf16 v46, v109, v3
    v_dot2c_f32_bf16 v47, v109, v7
    v_dot2c_f32_bf16 v44, v106, v4
    v_dot2c_f32_bf16 v45, v106, v8
    v_dot2c_f32_bf16 v46, v110, v4
    v_dot2c_f32_bf16 v47, v110, v8
    v_dot2c_f32_bf16 v44, v107, v5
    v_dot2c_f32_bf16 v45, v107, v9
    v_dot2c_f32_bf16 v46, v111, v5
    v_dot2c_f32_bf16 v47, v111, v9
    buffer_load_dwordx4 v[104:107], v38, s[60:63], s56 offen offset:2048 nt
    buffer_load_dwordx4 v[108:111], v38, s[60:63], s56 offen offset:3072 nt
    s_waitcnt vmcnt(14)
    v_dot2_f32_bf16 v48, v112, v2, 0
    v_dot2_f32_bf16 v49, v112, v6, 0
    v_dot2_f32_bf16 v50, v116, v2, 0
    v_dot2_f32_bf16 v51, v116, v6, 0
    v_dot2c_f32_bf16 v48, v113, v3
    v_dot2c_f32_bf16 v49, v113, v7
    v_dot2c_f32_bf16 v50, v117, v3
    v_dot2c_f32_bf16 v51, v117, v7
    v_dot2c_f32_bf16 v48, v114, v4
    v_dot2c_f32_bf16 v49, v114, v8
    v_dot2c_f32_bf16 v50, v118, v4
    v_dot2c_f32_bf16 v51, v118, v8
    v_dot2c_f32_bf16 v48, v115, v5
    v_dot2c_f32_bf16 v49, v115, v9
    v_dot2c_f32_bf16 v50, v119, v5
    v_dot2c_f32_bf16 v51, v119, v9
    buffer_load_dwordx4 v[112:115], v38, s[52:55], s57 offen offset:0 nt
    buffer_load_dwordx4 v[116:119], v38, s[52:55], s57 offen offset:1024 nt
    s_waitcnt vmcnt(14)
    v_dot2_f32_bf16 v52, v120, v2, 0
    v_dot2_f32_bf16 v53, v120, v6, 0
    v_dot2_f32_bf16 v54, v124, v2, 0
    v_dot2_f32_bf16 v55, v124, v6, 0
    v_dot2c_f32_bf16 v52, v121, v3
    v_dot2c_f32_bf16 v53, v121, v7
    v_dot2c_f32_bf16 v54, v125, v3
    v_dot2c_f32_bf16 v55, v125, v7
    v_dot2c_f32_bf16 v52, v122, v4
    v_dot2c_f32_bf16 v53, v122, v8
    v_dot2c_f32_bf16 v54, v126, v4
    v_dot2c_f32_bf16 v55, v126, v8
    v_dot2c_f32_bf16 v52, v123, v5
    v_dot2c_f32_bf16 v53, v123, v9
    v_dot2c_f32_bf16 v54, v127, v5
    v_dot2c_f32_bf16 v55, v127, v9
    buffer_load_dwordx4 v[120:123], v38, s[52:55], s57 offen offset:2048 nt
    buffer_load_dwordx4 v[124:127], v38, s[52:55], s57 offen offset:3072 nt
    v_add_f32_dpp v40, v40, v40 row_ror:8 row_mask:0xf bank_mask:0x3
    v_add_f32_dpp v40, v48, v48 row_ror:8 row_mask:0xf bank_mask:0xc
    v_add_f32_dpp v41, v41, v41 row_ror:8 row_mask:0xf bank_mask:0x3
    v_add_f32_dpp v41, v49, v49 row_ror:8 row_mask:0xf bank_mask:0xc
    v_add_f32_dpp v42, v42, v42 row_ror:8 row_mask:0xf bank_mask:0x3
    v_add_f32_dpp v42, v50, v50 row_ror:8 row_mask:0xf bank_mask:0xc
    v_add_f32_dpp v43, v43, v43 row_ror:8 row_mask:0xf bank_mask:0x3
    v_add_f32_dpp v43, v51, v51 row_ror:8 row_mask:0xf bank_mask:0xc
    v_add_f32_dpp v44, v44, v44 row_ror:8 row_mask:0xf bank_mask:0x3
    v_add_f32_dpp v44, v52, v52 row_ror:8 row_mask:0xf bank_mask:0xc
    v_add_f32_dpp v45, v45, v45 row_ror:8 row_mask:0xf bank_mask:0x3
    v_add_f32_dpp v45, v53, v53 row_ror:8 row_mask:0xf bank_mask:0xc
    v_add_f32_dpp v46, v46, v46 row_ror:8 row_mask:0xf bank_mask:0x3
    v_add_f32_dpp v46, v54, v54 row_ror:8 row_mask:0xf bank_mask:0xc
    v_add_f32_dpp v47, v47, v47 row_ror:8 row_mask:0xf bank_mask:0x3
    v_add_f32_dpp v47, v55, v55 row_ror:8 row_mask:0xf bank_mask:0xc
    v_add_f32_dpp v40, v40, v40 row_half_mirror row_mask:0xf bank_mask:0x5
    v_add_f32_dpp v40, v44, v44 row_half_mirror row_mask:0xf bank_mask:0xa
    v_add_f32_dpp v41, v41, v41 row_half_mirror row_mask:0xf bank_mask:0x5
    v_add_f32_dpp v41, v45, v45 row_half_mirror row_mask:0xf bank_mask:0xa
    v_add_f32_dpp v42, v42, v42 row_half_mirror row_mask:0xf bank_mask:0x5
    v_add_f32_dpp v42, v46, v46 row_half_mirror row_mask:0xf bank_mask:0xa
    v_add_f32_dpp v43, v43, v43 row_half_mirror row_mask:0xf bank_mask:0x5
    v_add_f32_dpp v43, v47, v47 row_half_mirror row_mask:0xf bank_mask:0xa
    v_add_f32_dpp v40, v40, v40 quad_perm:[1,0,3,2] row_mask:0xf bank_mask:0xf
    v_add_f32_dpp v41, v41, v41 quad_perm:[1,0,3,2] row_mask:0xf bank_mask:0xf
    v_add_f32_dpp v42, v42, v42 quad_perm:[1,0,3,2] row_mask:0xf bank_mask:0xf
    v_add_f32_dpp v43, v43, v43 quad_perm:[1,0,3,2] row_mask:0xf bank_mask:0xf
    v_add_f32_dpp v40, v40, v40 quad_perm:[2,3,0,1] row_mask:0xf bank_mask:0xf
    v_add_f32_dpp v41, v41, v41 quad_perm:[2,3,0,1] row_mask:0xf bank_mask:0xf
    v_add_f32_dpp v42, v42, v42 quad_perm:[2,3,0,1] row_mask:0xf bank_mask:0xf
    v_add_f32_dpp v43, v43, v43 quad_perm:[2,3,0,1] row_mask:0xf bank_mask:0xf
    v_cvt_pk_bf16_f32 v30, v40, v41
    v_cvt_pk_bf16_f32 v31, v42, v43
    v_add_u32 v13, s41, v162
    v_lshlrev_b32 v40, 16, v30
    v_and_b32 v41, 0xffff0000, v30
    v_lshlrev_b32 v42, 16, v31
    v_and_b32 v43, 0xffff0000, v31
    v_mul_f32 v40, s29, v40
    v_mul_f32 v41, s29, v41
    v_mul_f32 v42, s29, v42
    v_mul_f32 v43, s29, v43
    v_cvt_pk_bf16_f32 v56, v40, v41
    v_cvt_pk_bf16_f32 v57, v42, v43
    s_mov_b64 exec, s[58:59]
    ds_write_b64 v13, v[56:57]
    s_mov_b64 exec, -1
    s_mov_b32 s33, s47
    s_mov_b32 s41, s48
    s_waitcnt lgkmcnt(0)
    s_mov_b32 s37, 2147483647
    s_cmp_eq_u32 s45, 0
    s_cbranch_scc1 RG_k1
    v_readfirstlane_b32 s36, v161
    s_nop 3
    s_cmp_ge_u32 s36, 224
    s_cbranch_scc1 RP_k1
    s_sub_u32 s38, s36, 112
    s_cmp_lt_u32 s36, 112
    s_cselect_b32 s37, s36, s38
    s_cselect_b32 s47, 0, 1
    s_cselect_b64 s[60:61], s[12:13], s[16:17]
    s_cselect_b64 s[52:53], s[12:13], s[16:17]
    s_lshl_b32 s38, s37, 13
    s_add_u32 s56, s38, s27
    s_add_u32 s57, s56, 4096
    s_lshl_b32 s38, s37, 7
    s_add_u32 s48, s38, 0
    s_branch RD_k1
RP_k1:
    s_lshl_b32 s36, s36, 2
    s_add_u32 s36, s36, 15488
    s_mov_b32 s39, 0
    s_mov_b64 s[60:61], s[12:13]
    s_mov_b64 s[52:53], s[16:17]
RQ_k1:
    v_mov_b32 v161, s36
    ds_read_b32 v161, v161
    s_add_u32 s39, s39, 1
    s_waitcnt lgkmcnt(0)
    v_readfirstlane_b32 s37, v161
    s_nop 3
    s_cmp_lg_u32 s37, -1
    s_cbranch_scc1 RG_k1
    s_cmp_ge_u32 s39, 2097152
    s_cbranch_scc1 RG_k1
    s_sleep 1
    s_branch RQ_k1
RG_k1:
    s_and_b32 s38, s37, 15
    s_lshr_b32 s39, s37, 4
    s_lshl_b32 s38, s38, 20
    s_lshl_b32 s39, s39, 12
    s_add_u32 s38, s38, s39
    s_add_u32 s38, s38, s10
    s_add_u32 s38, s38, 917504
    s_cmp_lt_u32 s37, 512
    s_cselect_b32 s56, s38, 2147418112
    s_cselect_b32 s47, 2, 3
    s_cselect_b32 s45, s45, 0
    s_xor_b32 s57, s56, 0
RD_k1:
    s_branch K_loop
VS_0:
    s_add_u32 s39, s39, 1
    s_cmp_ge_u32 s39, 2097152
    s_cbranch_scc1 VC_0
    s_sleep 2
    s_branch VR_0
VS_1:
    s_add_u32 s39, s39, 1
    s_cmp_ge_u32 s39, 2097152
    s_cbranch_scc1 VC_1
    s_sleep 2
    s_branch VR_1
V_loop:
VL_0:
    s_cmp_lg_u32 s32, 1
    s_cbranch_scc1 PL_0
    s_cmp_eq_u32 s45, 0
    s_cbranch_scc1 CL_3
    v_mov_b32 v161, 1
    s_mov_b64 exec, 1
    ds_add_rtn_u32 v161, v160, v161
    s_mov_b64 exec, -1
CL_3:
    v_add_u32 v13, s40, v162
    v_mov_b32 v164, 0
    s_mov_b32 s39, 0
VR_0:
    ds_read_u16_d16_hi v164, v13
    s_waitcnt lgkmcnt(0)
    v_cmp_eq_u32 vcc, 0xffff0000, v164
    v_max_f32_dpp v165, v164, v164 quad_perm:[2,3,0,1] row_mask:0xf bank_mask:0xf
    s_nop 1
    v_max_f32_dpp v165, v165, v165 row_ror:4 row_mask:0xf bank_mask:0xf
    s_cbranch_vccnz VS_0
VC_0:
    s_nop 0
    v_max_f32_dpp v165, v165, v165 row_ror:8 row_mask:0xf bank_mask:0xf
    v_max_f32 v165, v165, v10
    v_sub_f32 v12, v10, v165
    v_sub_f32 v164, v164, v165
    v_mul_f32 v12, s30, v12
    v_mul_f32 v164, s30, v164
    v_exp_f32 v12, v12
    v_exp_f32 v164, v164
    v_mov_b32 v10, v165
    v_cmp_neq_f32 vcc, 1.0, v12
    v_mul_f32 v11, v11, v12
    v_add_f32 v11, v11, v164
    v_mov_b32_dpp v40, v164 row_newbcast:0 row_mask:0xf bank_mask:0xf
    v_mov_b32_dpp v41, v164 row_newbcast:1 row_mask:0xf bank_mask:0xf
    v_mov_b32_dpp v42, v164 row_newbcast:2 row_mask:0xf bank_mask:0xf
    v_mov_b32_dpp v43, v164 row_newbcast:3 row_mask:0xf bank_mask:0xf
    v_mov_b32_dpp v44, v164 row_newbcast:4 row_mask:0xf bank_mask:0xf
    v_mov_b32_dpp v45, v164 row_newbcast:5 row_mask:0xf bank_mask:0xf
    v_mov_b32_dpp v46, v164 row_newbcast:6 row_mask:0xf bank_mask:0xf
    v_mov_b32_dpp v47, v164 row_newbcast:7 row_mask:0xf bank_mask:0xf
    v_mov_b32_dpp v48, v164 row_newbcast:8 row_mask:0xf bank_mask:0xf
    v_mov_b32_dpp v49, v164 row_newbcast:9 row_mask:0xf bank_mask:0xf
    v_mov_b32_dpp v50, v164 row_newbcast:10 row_mask:0xf bank_mask:0xf
    v_mov_b32_dpp v51, v164 row_newbcast:11 row_mask:0xf bank_mask:0xf
    v_mov_b32_dpp v52, v164 row_newbcast:12 row_mask:0xf bank_mask:0xf
    v_mov_b32_dpp v53, v164 row_newbcast:13 row_mask:0xf bank_mask:0xf
    v_mov_b32_dpp v54, v164 row_newbcast:14 row_mask:0xf bank_mask:0xf
    v_mov_b32_dpp v55, v164 row_newbcast:15 row_mask:0xf bank_mask:0xf
    s_cbranch_vccz VN_v0
    v_mov_b32_dpp v166, v12 row_newbcast:0 row_mask:0xf bank_mask:0xf
    v_mov_b32_dpp v167, v12 row_newbcast:1 row_mask:0xf bank_mask:0xf
    v_pk_mul_f32 v[14:15], v[14:15], v[166:167] op_sel:[0,0] op_sel_hi:[1,0]
    v_pk_mul_f32 v[16:17], v[16:17], v[166:167] op_sel:[0,0] op_sel_hi:[1,0]
    v_pk_mul_f32 v[18:19], v[18:19], v[166:167] op_sel:[0,0] op_sel_hi:[1,0]
    v_pk_mul_f32 v[20:21], v[20:21], v[166:167] op_sel:[0,0] op_sel_hi:[1,0]
    v_pk_mul_f32 v[22:23], v[22:23], v[166:167] op_sel:[0,1] op_sel_hi:[1,1]
    v_pk_mul_f32 v[24:25], v[24:25], v[166:167] op_sel:[0,1] op_sel_hi:[1,1]
    v_pk_mul_f32 v[26:27], v[26:27], v[166:167] op_sel:[0,1] op_sel_hi:[1,1]
    v_pk_mul_f32 v[28:29], v[28:29], v[166:167] op_sel:[0,1] op_sel_hi:[1,1]
VN_v0:
    s_waitcnt vmcnt(14)
    v_lshlrev_b32 v30, 16, v64
    v_and_b32 v31, 0xffff0000, v64
    v_lshlrev_b32 v32, 16, v65
    v_and_b32 v33, 0xffff0000, v65
    v_lshlrev_b32 v34, 16, v66
    v_and_b32 v35, 0xffff0000, v66
    v_lshlrev_b32 v36, 16, v67
    v_and_b32 v37, 0xffff0000, v67
    v_lshlrev_b32 v56, 16, v68
    v_and_b32 v57, 0xffff0000, v68
    v_lshlrev_b32 v58, 16, v69
    v_and_b32 v59, 0xffff0000, v69
    v_lshlrev_b32 v60, 16, v70
    v_and_b32 v61, 0xffff0000, v70
    v_lshlrev_b32 v62, 16, v71
    v_and_b32 v63, 0xffff0000, v71
    buffer_load_dwordx4 v[64:67], v38, s[60:63], s56 offen offset:0 nt
    buffer_load_dwordx4 v[68:71], v38, s[60:63], s56 offen offset:1024 nt
    v_pk_fma_f32 v[14:15], v[30:31], v[40:41], v[14:15] op_sel:[0,0,0] op_sel_hi:[1,0,1]
    v_pk_fma_f32 v[16:17], v[32:33], v[40:41], v[16:17] op_sel:[0,0,0] op_sel_hi:[1,0,1]
    v_pk_fma_f32 v[18:19], v[34:35], v[40:41], v[18:19] op_sel:[0,0,0] op_sel_hi:[1,0,1]
    v_pk_fma_f32 v[20:21], v[36:37], v[40:41], v[20:21] op_sel:[0,0,0] op_sel_hi:[1,0,1]
    v_pk_fma_f32 v[22:23], v[30:31], v[40:41], v[22:23] op_sel:[0,1,0] op_sel_hi:[1,1,1]
    v_pk_fma_f32 v[24:25], v[32:33], v[40:41], v[24:25] op_sel:[0,1,0] op_sel_hi:[1,1,1]
    v_pk_fma_f32 v[26:27], v[34:35], v[40:41], v[26:27] op_sel:[0,1,0] op_sel_hi:[1,1,1]
    v_pk_fma_f32 v[28:29], v[36:37], v[40:41], v[28:29] op_sel:[0,1,0] op_sel_hi:[1,1,1]
    v_pk_fma_f32 v[14:15], v[56:57], v[42:43], v[14:15] op_sel:[0,0,0] op_sel_hi:[1,0,1]
    v_pk_fma_f32 v[16:17], v[58:59], v[42:43], v[16:17] op_sel:[0,0,0] op_sel_hi:[1,0,1]
    v_pk_fma_f32 v[18:19], v[60:61], v[42:43], v[18:19] op_sel:[0,0,0] op_sel_hi:[1,0,1]
    v_pk_fma_f32 v[20:21], v[62:63], v[42:43], v[20:21] op_sel:[0,0,0] op_sel_hi:[1,0,1]
    v_pk_fma_f32 v[22:23], v[56:57], v[42:43], v[22:23] op_sel:[0,1,0] op_sel_hi:[1,1,1]
    v_pk_fma_f32 v[24:25], v[58:59], v[42:43], v[24:25] op_sel:[0,1,0] op_sel_hi:[1,1,1]
    v_pk_fma_f32 v[26:27], v[60:61], v[42:43], v[26:27] op_sel:[0,1,0] op_sel_hi:[1,1,1]
    v_pk_fma_f32 v[28:29], v[62:63], v[42:43], v[28:29] op_sel:[0,1,0] op_sel_hi:[1,1,1]
    s_waitcnt vmcnt(14)
    v_lshlrev_b32 v30, 16, v72
    v_and_b32 v31, 0xffff0000, v72
    v_lshlrev_b32 v32, 16, v73
    v_and_b32 v33, 0xffff0000, v73
    v_lshlrev_b32 v34, 16, v74
    v_and_b32 v35, 0xffff0000, v74
    v_lshlrev_b32 v36, 16, v75
    v_and_b32 v37, 0xffff0000, v75
    v_lshlrev_b32 v56, 16, v76
    v_and_b32 v57, 0xffff0000, v76
    v_lshlrev_b32 v58, 16, v77
    v_and_b32 v59, 0xffff0000, v77
    v_lshlrev_b32 v60, 16, v78
    v_and_b32 v61, 0xffff0000, v78
    v_lshlrev_b32 v62, 16, v79
    v_and_b32 v63, 0xffff0000, v79
    buffer_load_dwordx4 v[72:75], v38, s[60:63], s56 offen offset:2048 nt
    buffer_load_dwordx4 v[76:79], v38, s[60:63], s56 offen offset:3072 nt
    v_pk_fma_f32 v[14:15], v[30:31], v[44:45], v[14:15] op_sel:[0,0,0] op_sel_hi:[1,0,1]
    v_pk_fma_f32 v[16:17], v[32:33], v[44:45], v[16:17] op_sel:[0,0,0] op_sel_hi:[1,0,1]
    v_pk_fma_f32 v[18:19], v[34:35], v[44:45], v[18:19] op_sel:[0,0,0] op_sel_hi:[1,0,1]
    v_pk_fma_f32 v[20:21], v[36:37], v[44:45], v[20:21] op_sel:[0,0,0] op_sel_hi:[1,0,1]
    v_pk_fma_f32 v[22:23], v[30:31], v[44:45], v[22:23] op_sel:[0,1,0] op_sel_hi:[1,1,1]
    v_pk_fma_f32 v[24:25], v[32:33], v[44:45], v[24:25] op_sel:[0,1,0] op_sel_hi:[1,1,1]
    v_pk_fma_f32 v[26:27], v[34:35], v[44:45], v[26:27] op_sel:[0,1,0] op_sel_hi:[1,1,1]
    v_pk_fma_f32 v[28:29], v[36:37], v[44:45], v[28:29] op_sel:[0,1,0] op_sel_hi:[1,1,1]
    v_pk_fma_f32 v[14:15], v[56:57], v[46:47], v[14:15] op_sel:[0,0,0] op_sel_hi:[1,0,1]
    v_pk_fma_f32 v[16:17], v[58:59], v[46:47], v[16:17] op_sel:[0,0,0] op_sel_hi:[1,0,1]
    v_pk_fma_f32 v[18:19], v[60:61], v[46:47], v[18:19] op_sel:[0,0,0] op_sel_hi:[1,0,1]
    v_pk_fma_f32 v[20:21], v[62:63], v[46:47], v[20:21] op_sel:[0,0,0] op_sel_hi:[1,0,1]
    v_pk_fma_f32 v[22:23], v[56:57], v[46:47], v[22:23] op_sel:[0,1,0] op_sel_hi:[1,1,1]
    v_pk_fma_f32 v[24:25], v[58:59], v[46:47], v[24:25] op_sel:[0,1,0] op_sel_hi:[1,1,1]
    v_pk_fma_f32 v[26:27], v[60:61], v[46:47], v[26:27] op_sel:[0,1,0] op_sel_hi:[1,1,1]
    v_pk_fma_f32 v[28:29], v[62:63], v[46:47], v[28:29] op_sel:[0,1,0] op_sel_hi:[1,1,1]
    s_waitcnt vmcnt(14)
    v_lshlrev_b32 v30, 16, v80
    v_and_b32 v31, 0xffff0000, v80
    v_lshlrev_b32 v32, 16, v81
    v_and_b32 v33, 0xffff0000, v81
    v_lshlrev_b32 v34, 16, v82
    v_and_b32 v35, 0xffff0000, v82
    v_lshlrev_b32 v36, 16, v83
    v_and_b32 v37, 0xffff0000, v83
    v_lshlrev_b32 v56, 16, v84
    v_and_b32 v57, 0xffff0000, v84
    v_lshlrev_b32 v58, 16, v85
    v_and_b32 v59, 0xffff0000, v85
    v_lshlrev_b32 v60, 16, v86
    v_and_b32 v61, 0xffff0000, v86
    v_lshlrev_b32 v62, 16, v87
    v_and_b32 v63, 0xffff0000, v87
    buffer_load_dwordx4 v[80:83], v38, s[52:55], s57 offen offset:0 nt
    buffer_load_dwordx4 v[84:87], v38, s[52:55], s57 offen offset:1024 nt
    v_pk_fma_f32 v[14:15], v[30:31], v[48:49], v[14:15] op_sel:[0,0,0] op_sel_hi:[1,0,1]
    v_pk_fma_f32 v[16:17], v[32:33], v[48:49], v[16:17] op_sel:[0,0,0] op_sel_hi:[1,0,1]
    v_pk_fma_f32 v[18:19], v[34:35], v[48:49], v[18:19] op_sel:[0,0,0] op_sel_hi:[1,0,1]
    v_pk_fma_f32 v[20:21], v[36:37], v[48:49], v[20:21] op_sel:[0,0,0] op_sel_hi:[1,0,1]
    v_pk_fma_f32 v[22:23], v[30:31], v[48:49], v[22:23] op_sel:[0,1,0] op_sel_hi:[1,1,1]
    v_pk_fma_f32 v[24:25], v[32:33], v[48:49], v[24:25] op_sel:[0,1,0] op_sel_hi:[1,1,1]
    v_pk_fma_f32 v[26:27], v[34:35], v[48:49], v[26:27] op_sel:[0,1,0] op_sel_hi:[1,1,1]
    v_pk_fma_f32 v[28:29], v[36:37], v[48:49], v[28:29] op_sel:[0,1,0] op_sel_hi:[1,1,1]
    v_pk_fma_f32 v[14:15], v[56:57], v[50:51], v[14:15] op_sel:[0,0,0] op_sel_hi:[1,0,1]
    v_pk_fma_f32 v[16:17], v[58:59], v[50:51], v[16:17] op_sel:[0,0,0] op_sel_hi:[1,0,1]
    v_pk_fma_f32 v[18:19], v[60:61], v[50:51], v[18:19] op_sel:[0,0,0] op_sel_hi:[1,0,1]
    v_pk_fma_f32 v[20:21], v[62:63], v[50:51], v[20:21] op_sel:[0,0,0] op_sel_hi:[1,0,1]
    v_pk_fma_f32 v[22:23], v[56:57], v[50:51], v[22:23] op_sel:[0,1,0] op_sel_hi:[1,1,1]
    v_pk_fma_f32 v[24:25], v[58:59], v[50:51], v[24:25] op_sel:[0,1,0] op_sel_hi:[1,1,1]
    v_pk_fma_f32 v[26:27], v[60:61], v[50:51], v[26:27] op_sel:[0,1,0] op_sel_hi:[1,1,1]
    v_pk_fma_f32 v[28:29], v[62:63], v[50:51], v[28:29] op_sel:[0,1,0] op_sel_hi:[1,1,1]
    s_waitcnt vmcnt(14)
    v_lshlrev_b32 v30, 16, v88
    v_and_b32 v31, 0xffff0000, v88
    v_lshlrev_b32 v32, 16, v89
    v_and_b32 v33, 0xffff0000, v89
    v_lshlrev_b32 v34, 16, v90
    v_and_b32 v35, 0xffff0000, v90
    v_lshlrev_b32 v36, 16, v91
    v_and_b32 v37, 0xffff0000, v91
    v_lshlrev_b32 v56, 16, v92
    v_and_b32 v57, 0xffff0000, v92
    v_lshlrev_b32 v58, 16, v93
    v_and_b32 v59, 0xffff0000, v93
    v_lshlrev_b32 v60, 16, v94
    v_and_b32 v61, 0xffff0000, v94
    v_lshlrev_b32 v62, 16, v95
    v_and_b32 v63, 0xffff0000, v95
    buffer_load_dwordx4 v[88:91], v38, s[52:55], s57 offen offset:2048 nt
    buffer_load_dwordx4 v[92:95], v38, s[52:55], s57 offen offset:3072 nt
    v_pk_fma_f32 v[14:15], v[30:31], v[52:53], v[14:15] op_sel:[0,0,0] op_sel_hi:[1,0,1]
    v_pk_fma_f32 v[16:17], v[32:33], v[52:53], v[16:17] op_sel:[0,0,0] op_sel_hi:[1,0,1]
    v_pk_fma_f32 v[18:19], v[34:35], v[52:53], v[18:19] op_sel:[0,0,0] op_sel_hi:[1,0,1]
    v_pk_fma_f32 v[20:21], v[36:37], v[52:53], v[20:21] op_sel:[0,0,0] op_sel_hi:[1,0,1]
    v_pk_fma_f32 v[22:23], v[30:31], v[52:53], v[22:23] op_sel:[0,1,0] op_sel_hi:[1,1,1]
    v_pk_fma_f32 v[24:25], v[32:33], v[52:53], v[24:25] op_sel:[0,1,0] op_sel_hi:[1,1,1]
    v_pk_fma_f32 v[26:27], v[34:35], v[52:53], v[26:27] op_sel:[0,1,0] op_sel_hi:[1,1,1]
    v_pk_fma_f32 v[28:29], v[36:37], v[52:53], v[28:29] op_sel:[0,1,0] op_sel_hi:[1,1,1]
    v_pk_fma_f32 v[14:15], v[56:57], v[54:55], v[14:15] op_sel:[0,0,0] op_sel_hi:[1,0,1]
    v_pk_fma_f32 v[16:17], v[58:59], v[54:55], v[16:17] op_sel:[0,0,0] op_sel_hi:[1,0,1]
    v_pk_fma_f32 v[18:19], v[60:61], v[54:55], v[18:19] op_sel:[0,0,0] op_sel_hi:[1,0,1]
    v_pk_fma_f32 v[20:21], v[62:63], v[54:55], v[20:21] op_sel:[0,0,0] op_sel_hi:[1,0,1]
    v_pk_fma_f32 v[22:23], v[56:57], v[54:55], v[22:23] op_sel:[0,1,0] op_sel_hi:[1,1,1]
    v_pk_fma_f32 v[24:25], v[58:59], v[54:55], v[24:25] op_sel:[0,1,0] op_sel_hi:[1,1,1]
    v_pk_fma_f32 v[26:27], v[60:61], v[54:55], v[26:27] op_sel:[0,1,0] op_sel_hi:[1,1,1]
    v_pk_fma_f32 v[28:29], v[62:63], v[54:55], v[28:29] op_sel:[0,1,0] op_sel_hi:[1,1,1]
    s_mov_b32 s32, s47
    s_mov_b32 s40, s48
    s_waitcnt lgkmcnt(0)
    s_mov_b32 s37, 2147483647
    s_cmp_eq_u32 s45, 0
    s_cbranch_scc1 RG_v0
    v_readfirstlane_b32 s36, v161
    s_nop 3
    s_cmp_ge_u32 s36, 224
    s_cbranch_scc1 RP_v0
    s_sub_u32 s38, s36, 112
    s_cmp_lt_u32 s36, 112
    s_cselect_b32 s37, s36, s38
    s_cselect_b32 s47, 0, 1
    s_cselect_b64 s[60:61], s[12:13], s[16:17]
    s_cselect_b64 s[52:53], s[12:13], s[16:17]
    s_lshl_b32 s38, s37, 13
    s_add_u32 s56, s38, s27
    s_add_u32 s57, s56, 4096
    s_lshl_b32 s38, s37, 7
    s_add_u32 s48, s38, 0
    s_branch RD_v0
RP_v0:
    s_lshl_b32 s36, s36, 2
    s_add_u32 s36, s36, 15488
    s_mov_b32 s39, 0
    s_mov_b64 s[60:61], s[12:13]
    s_mov_b64 s[52:53], s[16:17]
RQ_v0:
    v_mov_b32 v161, s36
    ds_read_b32 v161, v161
    s_add_u32 s39, s39, 1
    s_waitcnt lgkmcnt(0)
    v_readfirstlane_b32 s37, v161
    s_nop 3
    s_cmp_lg_u32 s37, -1
    s_cbranch_scc1 RG_v0
    s_cmp_ge_u32 s39, 2097152
    s_cbranch_scc1 RG_v0
    s_sleep 1
    s_branch RQ_v0
RG_v0:
    s_and_b32 s38, s37, 15
    s_lshr_b32 s39, s37, 4
    s_lshl_b32 s38, s38, 20
    s_lshl_b32 s39, s39, 12
    s_add_u32 s38, s38, s39
    s_add_u32 s38, s38, s10
    s_add_u32 s38, s38, 917504
    s_cmp_lt_u32 s37, 512
    s_cselect_b32 s56, s38, 2147418112
    s_cselect_b32 s47, 2, 3
    s_cselect_b32 s45, s45, 0
    s_xor_b32 s57, s56, 0
RD_v0:
VL_1:
    s_cmp_lg_u32 s33, 1
    s_cbranch_scc1 PL_1
    s_cmp_eq_u32 s45, 0
    s_cbranch_scc1 CL_4
    v_mov_b32 v161, 1
    s_mov_b64 exec, 1
    ds_add_rtn_u32 v161, v160, v161
    s_mov_b64 exec, -1
CL_4:
    v_add_u32 v13, s41, v162
    v_mov_b32 v164, 0
    s_mov_b32 s39, 0
VR_1:
    ds_read_u16_d16_hi v164, v13
    s_waitcnt lgkmcnt(0)
    v_cmp_eq_u32 vcc, 0xffff0000, v164
    v_max_f32_dpp v165, v164, v164 quad_perm:[2,3,0,1] row_mask:0xf bank_mask:0xf
    s_nop 1
    v_max_f32_dpp v165, v165, v165 row_ror:4 row_mask:0xf bank_mask:0xf
    s_cbranch_vccnz VS_1
VC_1:
    s_nop 0
    v_max_f32_dpp v165, v165, v165 row_ror:8 row_mask:0xf bank_mask:0xf
    v_max_f32 v165, v165, v10
    v_sub_f32 v12, v10, v165
    v_sub_f32 v164, v164, v165
    v_mul_f32 v12, s30, v12
    v_mul_f32 v164, s30, v164
    v_exp_f32 v12, v12
    v_exp_f32 v164, v164
    v_mov_b32 v10, v165
    v_cmp_neq_f32 vcc, 1.0, v12
    v_mul_f32 v11, v11, v12
    v_add_f32 v11, v11, v164
    v_mov_b32_dpp v40, v164 row_newbcast:0 row_mask:0xf bank_mask:0xf
    v_mov_b32_dpp v41, v164 row_newbcast:1 row_mask:0xf bank_mask:0xf
    v_mov_b32_dpp v42, v164 row_newbcast:2 row_mask:0xf bank_mask:0xf
    v_mov_b32_dpp v43, v164 row_newbcast:3 row_mask:0xf bank_mask:0xf
    v_mov_b32_dpp v44, v164 row_newbcast:4 row_mask:0xf bank_mask:0xf
    v_mov_b32_dpp v45, v164 row_newbcast:5 row_mask:0xf bank_mask:0xf
    v_mov_b32_dpp v46, v164 row_newbcast:6 row_mask:0xf bank_mask:0xf
    v_mov_b32_dpp v47, v164 row_newbcast:7 row_mask:0xf bank_mask:0xf
    v_mov_b32_dpp v48, v164 row_newbcast:8 row_mask:0xf bank_mask:0xf
    v_mov_b32_dpp v49, v164 row_newbcast:9 row_mask:0xf bank_mask:0xf
    v_mov_b32_dpp v50, v164 row_newbcast:10 row_mask:0xf bank_mask:0xf
    v_mov_b32_dpp v51, v164 row_newbcast:11 row_mask:0xf bank_mask:0xf
    v_mov_b32_dpp v52, v164 row_newbcast:12 row_mask:0xf bank_mask:0xf
    v_mov_b32_dpp v53, v164 row_newbcast:13 row_mask:0xf bank_mask:0xf
    v_mov_b32_dpp v54, v164 row_newbcast:14 row_mask:0xf bank_mask:0xf
    v_mov_b32_dpp v55, v164 row_newbcast:15 row_mask:0xf bank_mask:0xf
    s_cbranch_vccz VN_v1
    v_mov_b32_dpp v166, v12 row_newbcast:0 row_mask:0xf bank_mask:0xf
    v_mov_b32_dpp v167, v12 row_newbcast:1 row_mask:0xf bank_mask:0xf
    v_pk_mul_f32 v[14:15], v[14:15], v[166:167] op_sel:[0,0] op_sel_hi:[1,0]
    v_pk_mul_f32 v[16:17], v[16:17], v[166:167] op_sel:[0,0] op_sel_hi:[1,0]
    v_pk_mul_f32 v[18:19], v[18:19], v[166:167] op_sel:[0,0] op_sel_hi:[1,0]
    v_pk_mul_f32 v[20:21], v[20:21], v[166:167] op_sel:[0,0] op_sel_hi:[1,0]
    v_pk_mul_f32 v[22:23], v[22:23], v[166:167] op_sel:[0,1] op_sel_hi:[1,1]
    v_pk_mul_f32 v[24:25], v[24:25], v[166:167] op_sel:[0,1] op_sel_hi:[1,1]
    v_pk_mul_f32 v[26:27], v[26:27], v[166:167] op_sel:[0,1] op_sel_hi:[1,1]
    v_pk_mul_f32 v[28:29], v[28:29], v[166:167] op_sel:[0,1] op_sel_hi:[1,1]
VN_v1:
    s_waitcnt vmcnt(14)
    v_lshlrev_b32 v30, 16, v96
    v_and_b32 v31, 0xffff0000, v96
    v_lshlrev_b32 v32, 16, v97
    v_and_b32 v33, 0xffff0000, v97
    v_lshlrev_b32 v34, 16, v98
    v_and_b32 v35, 0xffff0000, v98
    v_lshlrev_b32 v36, 16, v99
    v_and_b32 v37, 0xffff0000, v99
    v_lshlrev_b32 v56, 16, v100
    v_and_b32 v57, 0xffff0000, v100
    v_lshlrev_b32 v58, 16, v101
    v_and_b32 v59, 0xffff0000, v101
    v_lshlrev_b32 v60, 16, v102
    v_and_b32 v61, 0xffff0000, v102
    v_lshlrev_b32 v62, 16, v103
    v_and_b32 v63, 0xffff0000, v103
    buffer_load_dwordx4 v[96:99], v38, s[60:63], s56 offen offset:0 nt
    buffer_load_dwordx4 v[100:103], v38, s[60:63], s56 offen offset:1024 nt
    v_pk_fma_f32 v[14:15], v[30:31], v[40:41], v[14:15] op_sel:[0,0,0] op_sel_hi:[1,0,1]
    v_pk_fma_f32 v[16:17], v[32:33], v[40:41], v[16:17] op_sel:[0,0,0] op_sel_hi:[1,0,1]
    v_pk_fma_f32 v[18:19], v[34:35], v[40:41], v[18:19] op_sel:[0,0,0] op_sel_hi:[1,0,1]
    v_pk_fma_f32 v[20:21], v[36:37], v[40:41], v[20:21] op_sel:[0,0,0] op_sel_hi:[1,0,1]
    v_pk_fma_f32 v[22:23], v[30:31], v[40:41], v[22:23] op_sel:[0,1,0] op_sel_hi:[1,1,1]
    v_pk_fma_f32 v[24:25], v[32:33], v[40:41], v[24:25] op_sel:[0,1,0] op_sel_hi:[1,1,1]
    v_pk_fma_f32 v[26:27], v[34:35], v[40:41], v[26:27] op_sel:[0,1,0] op_sel_hi:[1,1,1]
    v_pk_fma_f32 v[28:29], v[36:37], v[40:41], v[28:29] op_sel:[0,1,0] op_sel_hi:[1,1,1]
    v_pk_fma_f32 v[14:15], v[56:57], v[42:43], v[14:15] op_sel:[0,0,0] op_sel_hi:[1,0,1]
    v_pk_fma_f32 v[16:17], v[58:59], v[42:43], v[16:17] op_sel:[0,0,0] op_sel_hi:[1,0,1]
    v_pk_fma_f32 v[18:19], v[60:61], v[42:43], v[18:19] op_sel:[0,0,0] op_sel_hi:[1,0,1]
    v_pk_fma_f32 v[20:21], v[62:63], v[42:43], v[20:21] op_sel:[0,0,0] op_sel_hi:[1,0,1]
    v_pk_fma_f32 v[22:23], v[56:57], v[42:43], v[22:23] op_sel:[0,1,0] op_sel_hi:[1,1,1]
    v_pk_fma_f32 v[24:25], v[58:59], v[42:43], v[24:25] op_sel:[0,1,0] op_sel_hi:[1,1,1]
    v_pk_fma_f32 v[26:27], v[60:61], v[42:43], v[26:27] op_sel:[0,1,0] op_sel_hi:[1,1,1]
    v_pk_fma_f32 v[28:29], v[62:63], v[42:43], v[28:29] op_sel:[0,1,0] op_sel_hi:[1,1,1]
    s_waitcnt vmcnt(14)
    v_lshlrev_b32 v30, 16, v104
    v_and_b32 v31, 0xffff0000, v104
    v_lshlrev_b32 v32, 16, v105
    v_and_b32 v33, 0xffff0000, v105
    v_lshlrev_b32 v34, 16, v106
    v_and_b32 v35, 0xffff0000, v106
    v_lshlrev_b32 v36, 16, v107
    v_and_b32 v37, 0xffff0000, v107
    v_lshlrev_b32 v56, 16, v108
    v_and_b32 v57, 0xffff0000, v108
    v_lshlrev_b32 v58, 16, v109
    v_and_b32 v59, 0xffff0000, v109
    v_lshlrev_b32 v60, 16, v110
    v_and_b32 v61, 0xffff0000, v110
    v_lshlrev_b32 v62, 16, v111
    v_and_b32 v63, 0xffff0000, v111
    buffer_load_dwordx4 v[104:107], v38, s[60:63], s56 offen offset:2048 nt
    buffer_load_dwordx4 v[108:111], v38, s[60:63], s56 offen offset:3072 nt
    v_pk_fma_f32 v[14:15], v[30:31], v[44:45], v[14:15] op_sel:[0,0,0] op_sel_hi:[1,0,1]
    v_pk_fma_f32 v[16:17], v[32:33], v[44:45], v[16:17] op_sel:[0,0,0] op_sel_hi:[1,0,1]
    v_pk_fma_f32 v[18:19], v[34:35], v[44:45], v[18:19] op_sel:[0,0,0] op_sel_hi:[1,0,1]
    v_pk_fma_f32 v[20:21], v[36:37], v[44:45], v[20:21] op_sel:[0,0,0] op_sel_hi:[1,0,1]
    v_pk_fma_f32 v[22:23], v[30:31], v[44:45], v[22:23] op_sel:[0,1,0] op_sel_hi:[1,1,1]
    v_pk_fma_f32 v[24:25], v[32:33], v[44:45], v[24:25] op_sel:[0,1,0] op_sel_hi:[1,1,1]
    v_pk_fma_f32 v[26:27], v[34:35], v[44:45], v[26:27] op_sel:[0,1,0] op_sel_hi:[1,1,1]
    v_pk_fma_f32 v[28:29], v[36:37], v[44:45], v[28:29] op_sel:[0,1,0] op_sel_hi:[1,1,1]
    v_pk_fma_f32 v[14:15], v[56:57], v[46:47], v[14:15] op_sel:[0,0,0] op_sel_hi:[1,0,1]
    v_pk_fma_f32 v[16:17], v[58:59], v[46:47], v[16:17] op_sel:[0,0,0] op_sel_hi:[1,0,1]
    v_pk_fma_f32 v[18:19], v[60:61], v[46:47], v[18:19] op_sel:[0,0,0] op_sel_hi:[1,0,1]
    v_pk_fma_f32 v[20:21], v[62:63], v[46:47], v[20:21] op_sel:[0,0,0] op_sel_hi:[1,0,1]
    v_pk_fma_f32 v[22:23], v[56:57], v[46:47], v[22:23] op_sel:[0,1,0] op_sel_hi:[1,1,1]
    v_pk_fma_f32 v[24:25], v[58:59], v[46:47], v[24:25] op_sel:[0,1,0] op_sel_hi:[1,1,1]
    v_pk_fma_f32 v[26:27], v[60:61], v[46:47], v[26:27] op_sel:[0,1,0] op_sel_hi:[1,1,1]
    v_pk_fma_f32 v[28:29], v[62:63], v[46:47], v[28:29] op_sel:[0,1,0] op_sel_hi:[1,1,1]
    s_waitcnt vmcnt(14)
    v_lshlrev_b32 v30, 16, v112
    v_and_b32 v31, 0xffff0000, v112
    v_lshlrev_b32 v32, 16, v113
    v_and_b32 v33, 0xffff0000, v113
    v_lshlrev_b32 v34, 16, v114
    v_and_b32 v35, 0xffff0000, v114
    v_lshlrev_b32 v36, 16, v115
    v_and_b32 v37, 0xffff0000, v115
    v_lshlrev_b32 v56, 16, v116
    v_and_b32 v57, 0xffff0000, v116
    v_lshlrev_b32 v58, 16, v117
    v_and_b32 v59, 0xffff0000, v117
    v_lshlrev_b32 v60, 16, v118
    v_and_b32 v61, 0xffff0000, v118
    v_lshlrev_b32 v62, 16, v119
    v_and_b32 v63, 0xffff0000, v119
    buffer_load_dwordx4 v[112:115], v38, s[52:55], s57 offen offset:0 nt
    buffer_load_dwordx4 v[116:119], v38, s[52:55], s57 offen offset:1024 nt
    v_pk_fma_f32 v[14:15], v[30:31], v[48:49], v[14:15] op_sel:[0,0,0] op_sel_hi:[1,0,1]
    v_pk_fma_f32 v[16:17], v[32:33], v[48:49], v[16:17] op_sel:[0,0,0] op_sel_hi:[1,0,1]
    v_pk_fma_f32 v[18:19], v[34:35], v[48:49], v[18:19] op_sel:[0,0,0] op_sel_hi:[1,0,1]
    v_pk_fma_f32 v[20:21], v[36:37], v[48:49], v[20:21] op_sel:[0,0,0] op_sel_hi:[1,0,1]
    v_pk_fma_f32 v[22:23], v[30:31], v[48:49], v[22:23] op_sel:[0,1,0] op_sel_hi:[1,1,1]
    v_pk_fma_f32 v[24:25], v[32:33], v[48:49], v[24:25] op_sel:[0,1,0] op_sel_hi:[1,1,1]
    v_pk_fma_f32 v[26:27], v[34:35], v[48:49], v[26:27] op_sel:[0,1,0] op_sel_hi:[1,1,1]
    v_pk_fma_f32 v[28:29], v[36:37], v[48:49], v[28:29] op_sel:[0,1,0] op_sel_hi:[1,1,1]
    v_pk_fma_f32 v[14:15], v[56:57], v[50:51], v[14:15] op_sel:[0,0,0] op_sel_hi:[1,0,1]
    v_pk_fma_f32 v[16:17], v[58:59], v[50:51], v[16:17] op_sel:[0,0,0] op_sel_hi:[1,0,1]
    v_pk_fma_f32 v[18:19], v[60:61], v[50:51], v[18:19] op_sel:[0,0,0] op_sel_hi:[1,0,1]
    v_pk_fma_f32 v[20:21], v[62:63], v[50:51], v[20:21] op_sel:[0,0,0] op_sel_hi:[1,0,1]
    v_pk_fma_f32 v[22:23], v[56:57], v[50:51], v[22:23] op_sel:[0,1,0] op_sel_hi:[1,1,1]
    v_pk_fma_f32 v[24:25], v[58:59], v[50:51], v[24:25] op_sel:[0,1,0] op_sel_hi:[1,1,1]
    v_pk_fma_f32 v[26:27], v[60:61], v[50:51], v[26:27] op_sel:[0,1,0] op_sel_hi:[1,1,1]
    v_pk_fma_f32 v[28:29], v[62:63], v[50:51], v[28:29] op_sel:[0,1,0] op_sel_hi:[1,1,1]
    s_waitcnt vmcnt(14)
    v_lshlrev_b32 v30, 16, v120
    v_and_b32 v31, 0xffff0000, v120
    v_lshlrev_b32 v32, 16, v121
    v_and_b32 v33, 0xffff0000, v121
    v_lshlrev_b32 v34, 16, v122
    v_and_b32 v35, 0xffff0000, v122
    v_lshlrev_b32 v36, 16, v123
    v_and_b32 v37, 0xffff0000, v123
    v_lshlrev_b32 v56, 16, v124
    v_and_b32 v57, 0xffff0000, v124
    v_lshlrev_b32 v58, 16, v125
    v_and_b32 v59, 0xffff0000, v125
    v_lshlrev_b32 v60, 16, v126
    v_and_b32 v61, 0xffff0000, v126
    v_lshlrev_b32 v62, 16, v127
    v_and_b32 v63, 0xffff0000, v127
    buffer_load_dwordx4 v[120:123], v38, s[52:55], s57 offen offset:2048 nt
    buffer_load_dwordx4 v[124:127], v38, s[52:55], s57 offen offset:3072 nt
    v_pk_fma_f32 v[14:15], v[30:31], v[52:53], v[14:15] op_sel:[0,0,0] op_sel_hi:[1,0,1]
    v_pk_fma_f32 v[16:17], v[32:33], v[52:53], v[16:17] op_sel:[0,0,0] op_sel_hi:[1,0,1]
    v_pk_fma_f32 v[18:19], v[34:35], v[52:53], v[18:19] op_sel:[0,0,0] op_sel_hi:[1,0,1]
    v_pk_fma_f32 v[20:21], v[36:37], v[52:53], v[20:21] op_sel:[0,0,0] op_sel_hi:[1,0,1]
    v_pk_fma_f32 v[22:23], v[30:31], v[52:53], v[22:23] op_sel:[0,1,0] op_sel_hi:[1,1,1]
    v_pk_fma_f32 v[24:25], v[32:33], v[52:53], v[24:25] op_sel:[0,1,0] op_sel_hi:[1,1,1]
    v_pk_fma_f32 v[26:27], v[34:35], v[52:53], v[26:27] op_sel:[0,1,0] op_sel_hi:[1,1,1]
    v_pk_fma_f32 v[28:29], v[36:37], v[52:53], v[28:29] op_sel:[0,1,0] op_sel_hi:[1,1,1]
    v_pk_fma_f32 v[14:15], v[56:57], v[54:55], v[14:15] op_sel:[0,0,0] op_sel_hi:[1,0,1]
    v_pk_fma_f32 v[16:17], v[58:59], v[54:55], v[16:17] op_sel:[0,0,0] op_sel_hi:[1,0,1]
    v_pk_fma_f32 v[18:19], v[60:61], v[54:55], v[18:19] op_sel:[0,0,0] op_sel_hi:[1,0,1]
    v_pk_fma_f32 v[20:21], v[62:63], v[54:55], v[20:21] op_sel:[0,0,0] op_sel_hi:[1,0,1]
    v_pk_fma_f32 v[22:23], v[56:57], v[54:55], v[22:23] op_sel:[0,1,0] op_sel_hi:[1,1,1]
    v_pk_fma_f32 v[24:25], v[58:59], v[54:55], v[24:25] op_sel:[0,1,0] op_sel_hi:[1,1,1]
    v_pk_fma_f32 v[26:27], v[60:61], v[54:55], v[26:27] op_sel:[0,1,0] op_sel_hi:[1,1,1]
    v_pk_fma_f32 v[28:29], v[62:63], v[54:55], v[28:29] op_sel:[0,1,0] op_sel_hi:[1,1,1]
    s_mov_b32 s33, s47
    s_mov_b32 s41, s48
    s_waitcnt lgkmcnt(0)
    s_mov_b32 s37, 2147483647
    s_cmp_eq_u32 s45, 0
    s_cbranch_scc1 RG_v1
    v_readfirstlane_b32 s36, v161
    s_nop 3
    s_cmp_ge_u32 s36, 224
    s_cbranch_scc1 RP_v1
    s_sub_u32 s38, s36, 112
    s_cmp_lt_u32 s36, 112
    s_cselect_b32 s37, s36, s38
    s_cselect_b32 s47, 0, 1
    s_cselect_b64 s[60:61], s[12:13], s[16:17]
    s_cselect_b64 s[52:53], s[12:13], s[16:17]
    s_lshl_b32 s38, s37, 13
    s_add_u32 s56, s38, s27
    s_add_u32 s57, s56, 4096
    s_lshl_b32 s38, s37, 7
    s_add_u32 s48, s38, 0
    s_branch RD_v1
RP_v1:
    s_lshl_b32 s36, s36, 2
    s_add_u32 s36, s36, 15488
    s_mov_b32 s39, 0
    s_mov_b64 s[60:61], s[12:13]
    s_mov_b64 s[52:53], s[16:17]
RQ_v1:
    v_mov_b32 v161, s36
    ds_read_b32 v161, v161
    s_add_u32 s39, s39, 1
    s_waitcnt lgkmcnt(0)
    v_readfirstlane_b32 s37, v161
    s_nop 3
    s_cmp_lg_u32 s37, -1
    s_cbranch_scc1 RG_v1
    s_cmp_ge_u32 s39, 2097152
    s_cbranch_scc1 RG_v1
    s_sleep 1
    s_branch RQ_v1
RG_v1:
    s_and_b32 s38, s37, 15
    s_lshr_b32 s39, s37, 4
    s_lshl_b32 s38, s38, 20
    s_lshl_b32 s39, s39, 12
    s_add_u32 s38, s38, s39
    s_add_u32 s38, s38, s10
    s_add_u32 s38, s38, 917504
    s_cmp_lt_u32 s37, 512
    s_cselect_b32 s56, s38, 2147418112
    s_cselect_b32 s47, 2, 3
    s_cselect_b32 s45, s45, 0
    s_xor_b32 s57, s56, 0
RD_v1:
    s_branch V_loop
P_loop:
PL_0:
    s_cmp_eq_u32 s32, 3
    s_cbranch_scc1 K_done
    s_cmp_eq_u32 s45, 0
    s_cbranch_scc1 CL_5
    v_mov_b32 v161, 1
    s_mov_b64 exec, 1
    ds_add_rtn_u32 v161, v160, v161
    s_mov_b64 exec, -1
CL_5:
    s_waitcnt vmcnt(14)
    v_dot2_f32_bf16 v40, v64, v2, 0
    v_dot2_f32_bf16 v41, v64, v6, 0
    v_dot2_f32_bf16 v42, v68, v2, 0
    v_dot2_f32_bf16 v43, v68, v6, 0
    v_dot2c_f32_bf16 v40, v65, v3
    v_dot2c_f32_bf16 v41, v65, v7
    v_dot2c_f32_bf16 v42, v69, v3
    v_dot2c_f32_bf16 v43, v69, v7
    v_dot2c_f32_bf16 v40, v66, v4
    v_dot2c_f32_bf16 v41, v66, v8
    v_dot2c_f32_bf16 v42, v70, v4
    v_dot2c_f32_bf16 v43, v70, v8
    v_dot2c_f32_bf16 v40, v67, v5
    v_dot2c_f32_bf16 v41, v67, v9
    v_dot2c_f32_bf16 v42, v71, v5
    v_dot2c_f32_bf16 v43, v71, v9
    buffer_load_dwordx4 v[64:67], v38, s[60:63], s56 offen offset:0 nt
    buffer_load_dwordx4 v[68:71], v38, s[60:63], s56 offen offset:1024 nt
    s_waitcnt vmcnt(14)
    v_dot2_f32_bf16 v44, v72, v2, 0
    v_dot2_f32_bf16 v45, v72, v6, 0
    v_dot2_f32_bf16 v46, v76, v2, 0
    v_dot2_f32_bf16 v47, v76, v6, 0
    v_dot2c_f32_bf16 v44, v73, v3
    v_dot2c_f32_bf16 v45, v73, v7
    v_dot2c_f32_bf16 v46, v77, v3
    v_dot2c_f32_bf16 v47, v77, v7
    v_dot2c_f32_bf16 v44, v74, v4
    v_dot2c_f32_bf16 v45, v74, v8
    v_dot2c_f32_bf16 v46, v78, v4
    v_dot2c_f32_bf16 v47, v78, v8
    v_dot2c_f32_bf16 v44, v75, v5
    v_dot2c_f32_bf16 v45, v75, v9
    v_dot2c_f32_bf16 v46, v79, v5
    v_dot2c_f32_bf16 v47, v79, v9
    buffer_load_dwordx4 v[72:75], v38, s[60:63], s56 offen offset:2048 nt
    buffer_load_dwordx4 v[76:79], v38, s[60:63], s56 offen offset:3072 nt
    s_nop 1
    v_add_f32_dpp v40, v40, v40 row_ror:8 row_mask:0xf bank_mask:0x3
    v_add_f32_dpp v40, v44, v44 row_ror:8 row_mask:0xf bank_mask:0xc
    v_add_f32_dpp v41, v41, v41 row_ror:8 row_mask:0xf bank_mask:0x3
    v_add_f32_dpp v41, v45, v45 row_ror:8 row_mask:0xf bank_mask:0xc
    v_add_f32_dpp v42, v42, v42 row_ror:8 row_mask:0xf bank_mask:0x3
    v_add_f32_dpp v42, v46, v46 row_ror:8 row_mask:0xf bank_mask:0xc
    v_add_f32_dpp v43, v43, v43 row_ror:8 row_mask:0xf bank_mask:0x3
    v_add_f32_dpp v43, v47, v47 row_ror:8 row_mask:0xf bank_mask:0xc
    s_nop 1
    v_add_f32_dpp v40, v40, v40 row_half_mirror row_mask:0xf bank_mask:0x5
    v_add_f32_dpp v40, v42, v42 row_half_mirror row_mask:0xf bank_mask:0xa
    v_add_f32_dpp v41, v41, v41 row_half_mirror row_mask:0xf bank_mask:0x5
    v_add_f32_dpp v41, v43, v43 row_half_mirror row_mask:0xf bank_mask:0xa
    s_nop 1
    v_add_f32_dpp v40, v40, v40 quad_perm:[1,0,3,2] row_mask:0xf bank_mask:0xf
    v_add_f32_dpp v41, v41, v41 quad_perm:[1,0,3,2] row_mask:0xf bank_mask:0xf
    s_nop 1
    v_add_f32_dpp v40, v40, v40 quad_perm:[2,3,0,1] row_mask:0xf bank_mask:0xf
    v_add_f32_dpp v41, v41, v41 quad_perm:[2,3,0,1] row_mask:0xf bank_mask:0xf
    v_cvt_pk_bf16_f32 v30, v40, v41
    v_lshlrev_b32 v40, 16, v30
    v_and_b32 v41, 0xffff0000, v30
    v_mul_f32 v40, s29, v40
    v_mul_f32 v41, s29, v41
    v_cvt_pk_bf16_f32 v30, v40, v41
    v_lshlrev_b32 v40, 16, v30
    v_and_b32 v41, 0xffff0000, v30
    v_cndmask_b32 v164, v40, v41, s[0:1]
    s_nop 1
    v_max_f32_dpp v165, v164, v164 row_ror:4 row_mask:0xf bank_mask:0xf
    s_nop 0
    s_nop 0
    v_max_f32_dpp v165, v165, v165 row_ror:8 row_mask:0xf bank_mask:0xf
    v_max_f32 v165, v165, v10
    v_sub_f32 v12, v10, v165
    v_sub_f32 v164, v164, v165
    v_mul_f32 v12, s30, v12
    v_mul_f32 v164, s30, v164
    v_exp_f32 v12, v12
    v_exp_f32 v164, v164
    v_mov_b32 v10, v165
    v_cmp_neq_f32 vcc, 1.0, v12
    v_mul_f32 v11, v11, v12
    v_cndmask_b32 v165, 0, v164, s[50:51]
    v_add_f32 v11, v11, v165
    v_mov_b32_dpp v40, v164 row_newbcast:0 row_mask:0xf bank_mask:0xf
    v_mov_b32_dpp v41, v164 row_newbcast:1 row_mask:0xf bank_mask:0xf
    v_mov_b32_dpp v42, v164 row_newbcast:4 row_mask:0xf bank_mask:0xf
    v_mov_b32_dpp v43, v164 row_newbcast:5 row_mask:0xf bank_mask:0xf
    v_mov_b32_dpp v44, v164 row_newbcast:8 row_mask:0xf bank_mask:0xf
    v_mov_b32_dpp v45, v164 row_newbcast:9 row_mask:0xf bank_mask:0xf
    v_mov_b32_dpp v46, v164 row_newbcast:12 row_mask:0xf bank_mask:0xf
    v_mov_b32_dpp v47, v164 row_newbcast:13 row_mask:0xf bank_mask:0xf
    s_cbranch_vccz VN_p0
    v_mov_b32_dpp v166, v12 row_newbcast:0 row_mask:0xf bank_mask:0xf
    v_mov_b32_dpp v167, v12 row_newbcast:1 row_mask:0xf bank_mask:0xf
    v_pk_mul_f32 v[14:15], v[14:15], v[166:167] op_sel:[0,0] op_sel_hi:[1,0]
    v_pk_mul_f32 v[16:17], v[16:17], v[166:167] op_sel:[0,0] op_sel_hi:[1,0]
    v_pk_mul_f32 v[18:19], v[18:19], v[166:167] op_sel:[0,0] op_sel_hi:[1,0]
    v_pk_mul_f32 v[20:21], v[20:21], v[166:167] op_sel:[0,0] op_sel_hi:[1,0]
    v_pk_mul_f32 v[22:23], v[22:23], v[166:167] op_sel:[0,1] op_sel_hi:[1,1]
    v_pk_mul_f32 v[24:25], v[24:25], v[166:167] op_sel:[0,1] op_sel_hi:[1,1]
    v_pk_mul_f32 v[26:27], v[26:27], v[166:167] op_sel:[0,1] op_sel_hi:[1,1]
    v_pk_mul_f32 v[28:29], v[28:29], v[166:167] op_sel:[0,1] op_sel_hi:[1,1]
VN_p0:
    s_waitcnt vmcnt(14)
    v_lshlrev_b32 v30, 16, v80
    v_and_b32 v31, 0xffff0000, v80
    v_lshlrev_b32 v32, 16, v81
    v_and_b32 v33, 0xffff0000, v81
    v_lshlrev_b32 v34, 16, v82
    v_and_b32 v35, 0xffff0000, v82
    v_lshlrev_b32 v36, 16, v83
    v_and_b32 v37, 0xffff0000, v83
    v_lshlrev_b32 v56, 16, v84
    v_and_b32 v57, 0xffff0000, v84
    v_lshlrev_b32 v58, 16, v85
    v_and_b32 v59, 0xffff0000, v85
    v_lshlrev_b32 v60, 16, v86
    v_and_b32 v61, 0xffff0000, v86
    v_lshlrev_b32 v62, 16, v87
    v_and_b32 v63, 0xffff0000, v87
    buffer_load_dwordx4 v[80:83], v38, s[52:55], s57 offen offset:0 nt
    buffer_load_dwordx4 v[84:87], v38, s[52:55], s57 offen offset:1024 nt
    v_pk_fma_f32 v[14:15], v[30:31], v[40:41], v[14:15] op_sel:[0,0,0] op_sel_hi:[1,0,1]
    v_pk_fma_f32 v[16:17], v[32:33], v[40:41], v[16:17] op_sel:[0,0,0] op_sel_hi:[1,0,1]
    v_pk_fma_f32 v[18:19], v[34:35], v[40:41], v[18:19] op_sel:[0,0,0] op_sel_hi:[1,0,1]
    v_pk_fma_f32 v[20:21], v[36:37], v[40:41], v[20:21] op_sel:[0,0,0] op_sel_hi:[1,0,1]
    v_pk_fma_f32 v[22:23], v[30:31], v[40:41], v[22:23] op_sel:[0,1,0] op_sel_hi:[1,1,1]
    v_pk_fma_f32 v[24:25], v[32:33], v[40:41], v[24:25] op_sel:[0,1,0] op_sel_hi:[1,1,1]
    v_pk_fma_f32 v[26:27], v[34:35], v[40:41], v[26:27] op_sel:[0,1,0] op_sel_hi:[1,1,1]
    v_pk_fma_f32 v[28:29], v[36:37], v[40:41], v[28:29] op_sel:[0,1,0] op_sel_hi:[1,1,1]
    v_pk_fma_f32 v[14:15], v[56:57], v[42:43], v[14:15] op_sel:[0,0,0] op_sel_hi:[1,0,1]
    v_pk_fma_f32 v[16:17], v[58:59], v[42:43], v[16:17] op_sel:[0,0,0] op_sel_hi:[1,0,1]
    v_pk_fma_f32 v[18:19], v[60:61], v[42:43], v[18:19] op_sel:[0,0,0] op_sel_hi:[1,0,1]
    v_pk_fma_f32 v[20:21], v[62:63], v[42:43], v[20:21] op_sel:[0,0,0] op_sel_hi:[1,0,1]
    v_pk_fma_f32 v[22:23], v[56:57], v[42:43], v[22:23] op_sel:[0,1,0] op_sel_hi:[1,1,1]
    v_pk_fma_f32 v[24:25], v[58:59], v[42:43], v[24:25] op_sel:[0,1,0] op_sel_hi:[1,1,1]
    v_pk_fma_f32 v[26:27], v[60:61], v[42:43], v[26:27] op_sel:[0,1,0] op_sel_hi:[1,1,1]
    v_pk_fma_f32 v[28:29], v[62:63], v[42:43], v[28:29] op_sel:[0,1,0] op_sel_hi:[1,1,1]
    s_waitcnt vmcnt(14)
    v_lshlrev_b32 v30, 16, v88
    v_and_b32 v31, 0xffff0000, v88
    v_lshlrev_b32 v32, 16, v89
    v_and_b32 v33, 0xffff0000, v89
    v_lshlrev_b32 v34, 16, v90
    v_and_b32 v35, 0xffff0000, v90
    v_lshlrev_b32 v36, 16, v91
    v_and_b32 v37, 0xffff0000, v91
    v_lshlrev_b32 v56, 16, v92
    v_and_b32 v57, 0xffff0000, v92
    v_lshlrev_b32 v58, 16, v93
    v_and_b32 v59, 0xffff0000, v93
    v_lshlrev_b32 v60, 16, v94
    v_and_b32 v61, 0xffff0000, v94
    v_lshlrev_b32 v62, 16, v95
    v_and_b32 v63, 0xffff0000, v95
    buffer_load_dwordx4 v[88:91], v38, s[52:55], s57 offen offset:2048 nt
    buffer_load_dwordx4 v[92:95], v38, s[52:55], s57 offen offset:3072 nt
    v_pk_fma_f32 v[14:15], v[30:31], v[44:45], v[14:15] op_sel:[0,0,0] op_sel_hi:[1,0,1]
    v_pk_fma_f32 v[16:17], v[32:33], v[44:45], v[16:17] op_sel:[0,0,0] op_sel_hi:[1,0,1]
    v_pk_fma_f32 v[18:19], v[34:35], v[44:45], v[18:19] op_sel:[0,0,0] op_sel_hi:[1,0,1]
    v_pk_fma_f32 v[20:21], v[36:37], v[44:45], v[20:21] op_sel:[0,0,0] op_sel_hi:[1,0,1]
    v_pk_fma_f32 v[22:23], v[30:31], v[44:45], v[22:23] op_sel:[0,1,0] op_sel_hi:[1,1,1]
    v_pk_fma_f32 v[24:25], v[32:33], v[44:45], v[24:25] op_sel:[0,1,0] op_sel_hi:[1,1,1]
    v_pk_fma_f32 v[26:27], v[34:35], v[44:45], v[26:27] op_sel:[0,1,0] op_sel_hi:[1,1,1]
    v_pk_fma_f32 v[28:29], v[36:37], v[44:45], v[28:29] op_sel:[0,1,0] op_sel_hi:[1,1,1]
    v_pk_fma_f32 v[14:15], v[56:57], v[46:47], v[14:15] op_sel:[0,0,0] op_sel_hi:[1,0,1]
    v_pk_fma_f32 v[16:17], v[58:59], v[46:47], v[16:17] op_sel:[0,0,0] op_sel_hi:[1,0,1]
    v_pk_fma_f32 v[18:19], v[60:61], v[46:47], v[18:19] op_sel:[0,0,0] op_sel_hi:[1,0,1]
    v_pk_fma_f32 v[20:21], v[62:63], v[46:47], v[20:21] op_sel:[0,0,0] op_sel_hi:[1,0,1]
    v_pk_fma_f32 v[22:23], v[56:57], v[46:47], v[22:23] op_sel:[0,1,0] op_sel_hi:[1,1,1]
    v_pk_fma_f32 v[24:25], v[58:59], v[46:47], v[24:25] op_sel:[0,1,0] op_sel_hi:[1,1,1]
    v_pk_fma_f32 v[26:27], v[60:61], v[46:47], v[26:27] op_sel:[0,1,0] op_sel_hi:[1,1,1]
    v_pk_fma_f32 v[28:29], v[62:63], v[46:47], v[28:29] op_sel:[0,1,0] op_sel_hi:[1,1,1]
    s_mov_b32 s32, s47
    s_mov_b32 s40, s48
    s_cmp_eq_u32 s47, 3
    s_cbranch_scc1 RD_p0
    s_waitcnt lgkmcnt(0)
    s_mov_b32 s37, 2147483647
    s_cmp_eq_u32 s45, 0
    s_cbranch_scc1 RG_p0
    v_readfirstlane_b32 s36, v161
    s_nop 3
    s_cmp_ge_u32 s36, 224
    s_cbranch_scc1 RP_p0
    s_sub_u32 s38, s36, 112
    s_cmp_lt_u32 s36, 112
    s_cselect_b32 s37, s36, s38
    s_cselect_b32 s47, 0, 1
    s_cselect_b64 s[60:61], s[12:13], s[16:17]
    s_cselect_b64 s[52:53], s[12:13], s[16:17]
    s_lshl_b32 s38, s37, 13
    s_add_u32 s56, s38, s27
    s_add_u32 s57, s56, 4096
    s_lshl_b32 s38, s37, 7
    s_add_u32 s48, s38, 0
    s_branch RD_p0
RP_p0:
    s_lshl_b32 s36, s36, 2
    s_add_u32 s36, s36, 15488
    s_mov_b32 s39, 0
    s_mov_b64 s[60:61], s[12:13]
    s_mov_b64 s[52:53], s[16:17]
RQ_p0:
    v_mov_b32 v161, s36
    ds_read_b32 v161, v161
    s_add_u32 s39, s39, 1
    s_waitcnt lgkmcnt(0)
    v_readfirstlane_b32 s37, v161
    s_nop 3
    s_cmp_lg_u32 s37, -1
    s_cbranch_scc1 RG_p0
    s_cmp_ge_u32 s39, 2097152
    s_cbranch_scc1 RG_p0
    s_sleep 1
    s_branch RQ_p0
RG_p0:
    s_and_b32 s38, s37, 15
    s_lshr_b32 s39, s37, 4
    s_lshl_b32 s38, s38, 20
    s_lshl_b32 s39, s39, 12
    s_add_u32 s38, s38, s39
    s_add_u32 s38, s38, s10
    s_add_u32 s38, s38, 917504
    s_cmp_lt_u32 s37, 512
    s_cselect_b32 s56, s38, 2147418112
    s_cselect_b32 s47, 2, 3
    s_cselect_b32 s45, s45, 0
    s_xor_b32 s57, s56, 0
RD_p0:
PL_1:
    s_cmp_eq_u32 s33, 3
    s_cbranch_scc1 K_done
    s_cmp_eq_u32 s45, 0
    s_cbranch_scc1 CL_6
    v_mov_b32 v161, 1
    s_mov_b64 exec, 1
    ds_add_rtn_u32 v161, v160, v161
    s_mov_b64 exec, -1
CL_6:
    s_waitcnt vmcnt(14)
    v_dot2_f32_bf16 v40, v96, v2, 0
    v_dot2_f32_bf16 v41, v96, v6, 0
    v_dot2_f32_bf16 v42, v100, v2, 0
    v_dot2_f32_bf16 v43, v100, v6, 0
    v_dot2c_f32_bf16 v40, v97, v3
    v_dot2c_f32_bf16 v41, v97, v7
    v_dot2c_f32_bf16 v42, v101, v3
    v_dot2c_f32_bf16 v43, v101, v7
    v_dot2c_f32_bf16 v40, v98, v4
    v_dot2c_f32_bf16 v41, v98, v8
    v_dot2c_f32_bf16 v42, v102, v4
    v_dot2c_f32_bf16 v43, v102, v8
    v_dot2c_f32_bf16 v40, v99, v5
    v_dot2c_f32_bf16 v41, v99, v9
    v_dot2c_f32_bf16 v42, v103, v5
    v_dot2c_f32_bf16 v43, v103, v9
    buffer_load_dwordx4 v[96:99], v38, s[60:63], s56 offen offset:0 nt
    buffer_load_dwordx4 v[100:103], v38, s[60:63], s56 offen offset:1024 nt
    s_waitcnt vmcnt(14)
    v_dot2_f32_bf16 v44, v104, v2, 0
    v_dot2_f32_bf16 v45, v104, v6, 0
    v_dot2_f32_bf16 v46, v108, v2, 0
    v_dot2_f32_bf16 v47, v108, v6, 0
    v_dot2c_f32_bf16 v44, v105, v3
    v_dot2c_f32_bf16 v45, v105, v7
    v_dot2c_f32_bf16 v46, v109, v3
    v_dot2c_f32_bf16 v47, v109, v7
    v_dot2c_f32_bf16 v44, v106, v4
    v_dot2c_f32_bf16 v45, v106, v8
    v_dot2c_f32_bf16 v46, v110, v4
    v_dot2c_f32_bf16 v47, v110, v8
    v_dot2c_f32_bf16 v44, v107, v5
    v_dot2c_f32_bf16 v45, v107, v9
    v_dot2c_f32_bf16 v46, v111, v5
    v_dot2c_f32_bf16 v47, v111, v9
    buffer_load_dwordx4 v[104:107], v38, s[60:63], s56 offen offset:2048 nt
    buffer_load_dwordx4 v[108:111], v38, s[60:63], s56 offen offset:3072 nt
    s_nop 1
    v_add_f32_dpp v40, v40, v40 row_ror:8 row_mask:0xf bank_mask:0x3
    v_add_f32_dpp v40, v44, v44 row_ror:8 row_mask:0xf bank_mask:0xc
    v_add_f32_dpp v41, v41, v41 row_ror:8 row_mask:0xf bank_mask:0x3
    v_add_f32_dpp v41, v45, v45 row_ror:8 row_mask:0xf bank_mask:0xc
    v_add_f32_dpp v42, v42, v42 row_ror:8 row_mask:0xf bank_mask:0x3
    v_add_f32_dpp v42, v46, v46 row_ror:8 row_mask:0xf bank_mask:0xc
    v_add_f32_dpp v43, v43, v43 row_ror:8 row_mask:0xf bank_mask:0x3
    v_add_f32_dpp v43, v47, v47 row_ror:8 row_mask:0xf bank_mask:0xc
    s_nop 1
    v_add_f32_dpp v40, v40, v40 row_half_mirror row_mask:0xf bank_mask:0x5
    v_add_f32_dpp v40, v42, v42 row_half_mirror row_mask:0xf bank_mask:0xa
    v_add_f32_dpp v41, v41, v41 row_half_mirror row_mask:0xf bank_mask:0x5
    v_add_f32_dpp v41, v43, v43 row_half_mirror row_mask:0xf bank_mask:0xa
    s_nop 1
    v_add_f32_dpp v40, v40, v40 quad_perm:[1,0,3,2] row_mask:0xf bank_mask:0xf
    v_add_f32_dpp v41, v41, v41 quad_perm:[1,0,3,2] row_mask:0xf bank_mask:0xf
    s_nop 1
    v_add_f32_dpp v40, v40, v40 quad_perm:[2,3,0,1] row_mask:0xf bank_mask:0xf
    v_add_f32_dpp v41, v41, v41 quad_perm:[2,3,0,1] row_mask:0xf bank_mask:0xf
    v_cvt_pk_bf16_f32 v30, v40, v41
    v_lshlrev_b32 v40, 16, v30
    v_and_b32 v41, 0xffff0000, v30
    v_mul_f32 v40, s29, v40
    v_mul_f32 v41, s29, v41
    v_cvt_pk_bf16_f32 v30, v40, v41
    v_lshlrev_b32 v40, 16, v30
    v_and_b32 v41, 0xffff0000, v30
    v_cndmask_b32 v164, v40, v41, s[0:1]
    s_nop 1
    v_max_f32_dpp v165, v164, v164 row_ror:4 row_mask:0xf bank_mask:0xf
    s_nop 0
    s_nop 0
    v_max_f32_dpp v165, v165, v165 row_ror:8 row_mask:0xf bank_mask:0xf
    v_max_f32 v165, v165, v10
    v_sub_f32 v12, v10, v165
    v_sub_f32 v164, v164, v165
    v_mul_f32 v12, s30, v12
    v_mul_f32 v164, s30, v164
    v_exp_f32 v12, v12
    v_exp_f32 v164, v164
    v_mov_b32 v10, v165
    v_cmp_neq_f32 vcc, 1.0, v12
    v_mul_f32 v11, v11, v12
    v_cndmask_b32 v165, 0, v164, s[50:51]
    v_add_f32 v11, v11, v165
    v_mov_b32_dpp v40, v164 row_newbcast:0 row_mask:0xf bank_mask:0xf
    v_mov_b32_dpp v41, v164 row_newbcast:1 row_mask:0xf bank_mask:0xf
    v_mov_b32_dpp v42, v164 row_newbcast:4 row_mask:0xf bank_mask:0xf
    v_mov_b32_dpp v43, v164 row_newbcast:5 row_mask:0xf bank_mask:0xf
    v_mov_b32_dpp v44, v164 row_newbcast:8 row_mask:0xf bank_mask:0xf
    v_mov_b32_dpp v45, v164 row_newbcast:9 row_mask:0xf bank_mask:0xf
    v_mov_b32_dpp v46, v164 row_newbcast:12 row_mask:0xf bank_mask:0xf
    v_mov_b32_dpp v47, v164 row_newbcast:13 row_mask:0xf bank_mask:0xf
    s_cbranch_vccz VN_p1
    v_mov_b32_dpp v166, v12 row_newbcast:0 row_mask:0xf bank_mask:0xf
    v_mov_b32_dpp v167, v12 row_newbcast:1 row_mask:0xf bank_mask:0xf
    v_pk_mul_f32 v[14:15], v[14:15], v[166:167] op_sel:[0,0] op_sel_hi:[1,0]
    v_pk_mul_f32 v[16:17], v[16:17], v[166:167] op_sel:[0,0] op_sel_hi:[1,0]
    v_pk_mul_f32 v[18:19], v[18:19], v[166:167] op_sel:[0,0] op_sel_hi:[1,0]
    v_pk_mul_f32 v[20:21], v[20:21], v[166:167] op_sel:[0,0] op_sel_hi:[1,0]
    v_pk_mul_f32 v[22:23], v[22:23], v[166:167] op_sel:[0,1] op_sel_hi:[1,1]
    v_pk_mul_f32 v[24:25], v[24:25], v[166:167] op_sel:[0,1] op_sel_hi:[1,1]
    v_pk_mul_f32 v[26:27], v[26:27], v[166:167] op_sel:[0,1] op_sel_hi:[1,1]
    v_pk_mul_f32 v[28:29], v[28:29], v[166:167] op_sel:[0,1] op_sel_hi:[1,1]
VN_p1:
    s_waitcnt vmcnt(14)
    v_lshlrev_b32 v30, 16, v112
    v_and_b32 v31, 0xffff0000, v112
    v_lshlrev_b32 v32, 16, v113
    v_and_b32 v33, 0xffff0000, v113
    v_lshlrev_b32 v34, 16, v114
    v_and_b32 v35, 0xffff0000, v114
    v_lshlrev_b32 v36, 16, v115
    v_and_b32 v37, 0xffff0000, v115
    v_lshlrev_b32 v56, 16, v116
    v_and_b32 v57, 0xffff0000, v116
    v_lshlrev_b32 v58, 16, v117
    v_and_b32 v59, 0xffff0000, v117
    v_lshlrev_b32 v60, 16, v118
    v_and_b32 v61, 0xffff0000, v118
    v_lshlrev_b32 v62, 16, v119
    v_and_b32 v63, 0xffff0000, v119
    buffer_load_dwordx4 v[112:115], v38, s[52:55], s57 offen offset:0 nt
    buffer_load_dwordx4 v[116:119], v38, s[52:55], s57 offen offset:1024 nt
    v_pk_fma_f32 v[14:15], v[30:31], v[40:41], v[14:15] op_sel:[0,0,0] op_sel_hi:[1,0,1]
    v_pk_fma_f32 v[16:17], v[32:33], v[40:41], v[16:17] op_sel:[0,0,0] op_sel_hi:[1,0,1]
    v_pk_fma_f32 v[18:19], v[34:35], v[40:41], v[18:19] op_sel:[0,0,0] op_sel_hi:[1,0,1]
    v_pk_fma_f32 v[20:21], v[36:37], v[40:41], v[20:21] op_sel:[0,0,0] op_sel_hi:[1,0,1]
    v_pk_fma_f32 v[22:23], v[30:31], v[40:41], v[22:23] op_sel:[0,1,0] op_sel_hi:[1,1,1]
    v_pk_fma_f32 v[24:25], v[32:33], v[40:41], v[24:25] op_sel:[0,1,0] op_sel_hi:[1,1,1]
    v_pk_fma_f32 v[26:27], v[34:35], v[40:41], v[26:27] op_sel:[0,1,0] op_sel_hi:[1,1,1]
    v_pk_fma_f32 v[28:29], v[36:37], v[40:41], v[28:29] op_sel:[0,1,0] op_sel_hi:[1,1,1]
    v_pk_fma_f32 v[14:15], v[56:57], v[42:43], v[14:15] op_sel:[0,0,0] op_sel_hi:[1,0,1]
    v_pk_fma_f32 v[16:17], v[58:59], v[42:43], v[16:17] op_sel:[0,0,0] op_sel_hi:[1,0,1]
    v_pk_fma_f32 v[18:19], v[60:61], v[42:43], v[18:19] op_sel:[0,0,0] op_sel_hi:[1,0,1]
    v_pk_fma_f32 v[20:21], v[62:63], v[42:43], v[20:21] op_sel:[0,0,0] op_sel_hi:[1,0,1]
    v_pk_fma_f32 v[22:23], v[56:57], v[42:43], v[22:23] op_sel:[0,1,0] op_sel_hi:[1,1,1]
    v_pk_fma_f32 v[24:25], v[58:59], v[42:43], v[24:25] op_sel:[0,1,0] op_sel_hi:[1,1,1]
    v_pk_fma_f32 v[26:27], v[60:61], v[42:43], v[26:27] op_sel:[0,1,0] op_sel_hi:[1,1,1]
    v_pk_fma_f32 v[28:29], v[62:63], v[42:43], v[28:29] op_sel:[0,1,0] op_sel_hi:[1,1,1]
    s_waitcnt vmcnt(14)
    v_lshlrev_b32 v30, 16, v120
    v_and_b32 v31, 0xffff0000, v120
    v_lshlrev_b32 v32, 16, v121
    v_and_b32 v33, 0xffff0000, v121
    v_lshlrev_b32 v34, 16, v122
    v_and_b32 v35, 0xffff0000, v122
    v_lshlrev_b32 v36, 16, v123
    v_and_b32 v37, 0xffff0000, v123
    v_lshlrev_b32 v56, 16, v124
    v_and_b32 v57, 0xffff0000, v124
    v_lshlrev_b32 v58, 16, v125
    v_and_b32 v59, 0xffff0000, v125
    v_lshlrev_b32 v60, 16, v126
    v_and_b32 v61, 0xffff0000, v126
    v_lshlrev_b32 v62, 16, v127
    v_and_b32 v63, 0xffff0000, v127
    buffer_load_dwordx4 v[120:123], v38, s[52:55], s57 offen offset:2048 nt
    buffer_load_dwordx4 v[124:127], v38, s[52:55], s57 offen offset:3072 nt
    v_pk_fma_f32 v[14:15], v[30:31], v[44:45], v[14:15] op_sel:[0,0,0] op_sel_hi:[1,0,1]
    v_pk_fma_f32 v[16:17], v[32:33], v[44:45], v[16:17] op_sel:[0,0,0] op_sel_hi:[1,0,1]
    v_pk_fma_f32 v[18:19], v[34:35], v[44:45], v[18:19] op_sel:[0,0,0] op_sel_hi:[1,0,1]
    v_pk_fma_f32 v[20:21], v[36:37], v[44:45], v[20:21] op_sel:[0,0,0] op_sel_hi:[1,0,1]
    v_pk_fma_f32 v[22:23], v[30:31], v[44:45], v[22:23] op_sel:[0,1,0] op_sel_hi:[1,1,1]
    v_pk_fma_f32 v[24:25], v[32:33], v[44:45], v[24:25] op_sel:[0,1,0] op_sel_hi:[1,1,1]
    v_pk_fma_f32 v[26:27], v[34:35], v[44:45], v[26:27] op_sel:[0,1,0] op_sel_hi:[1,1,1]
    v_pk_fma_f32 v[28:29], v[36:37], v[44:45], v[28:29] op_sel:[0,1,0] op_sel_hi:[1,1,1]
    v_pk_fma_f32 v[14:15], v[56:57], v[46:47], v[14:15] op_sel:[0,0,0] op_sel_hi:[1,0,1]
    v_pk_fma_f32 v[16:17], v[58:59], v[46:47], v[16:17] op_sel:[0,0,0] op_sel_hi:[1,0,1]
    v_pk_fma_f32 v[18:19], v[60:61], v[46:47], v[18:19] op_sel:[0,0,0] op_sel_hi:[1,0,1]
    v_pk_fma_f32 v[20:21], v[62:63], v[46:47], v[20:21] op_sel:[0,0,0] op_sel_hi:[1,0,1]
    v_pk_fma_f32 v[22:23], v[56:57], v[46:47], v[22:23] op_sel:[0,1,0] op_sel_hi:[1,1,1]
    v_pk_fma_f32 v[24:25], v[58:59], v[46:47], v[24:25] op_sel:[0,1,0] op_sel_hi:[1,1,1]
    v_pk_fma_f32 v[26:27], v[60:61], v[46:47], v[26:27] op_sel:[0,1,0] op_sel_hi:[1,1,1]
    v_pk_fma_f32 v[28:29], v[62:63], v[46:47], v[28:29] op_sel:[0,1,0] op_sel_hi:[1,1,1]
    s_mov_b32 s33, s47
    s_mov_b32 s41, s48
    s_cmp_eq_u32 s47, 3
    s_cbranch_scc1 RD_p1
    s_waitcnt lgkmcnt(0)
    s_mov_b32 s37, 2147483647
    s_cmp_eq_u32 s45, 0
    s_cbranch_scc1 RG_p1
    v_readfirstlane_b32 s36, v161
    s_nop 3
    s_cmp_ge_u32 s36, 224
    s_cbranch_scc1 RP_p1
    s_sub_u32 s38, s36, 112
    s_cmp_lt_u32 s36, 112
    s_cselect_b32 s37, s36, s38
    s_cselect_b32 s47, 0, 1
    s_cselect_b64 s[60:61], s[12:13], s[16:17]
    s_cselect_b64 s[52:53], s[12:13], s[16:17]
    s_lshl_b32 s38, s37, 13
    s_add_u32 s56, s38, s27
    s_add_u32 s57, s56, 4096
    s_lshl_b32 s38, s37, 7
    s_add_u32 s48, s38, 0
    s_branch RD_p1
RP_p1:
    s_lshl_b32 s36, s36, 2
    s_add_u32 s36, s36, 15488
    s_mov_b32 s39, 0
    s_mov_b64 s[60:61], s[12:13]
    s_mov_b64 s[52:53], s[16:17]
RQ_p1:
    v_mov_b32 v161, s36
    ds_read_b32 v161, v161
    s_add_u32 s39, s39, 1
    s_waitcnt lgkmcnt(0)
    v_readfirstlane_b32 s37, v161
    s_nop 3
    s_cmp_lg_u32 s37, -1
    s_cbranch_scc1 RG_p1
    s_cmp_ge_u32 s39, 2097152
    s_cbranch_scc1 RG_p1
    s_sleep 1
    s_branch RQ_p1
RG_p1:
    s_and_b32 s38, s37, 15
    s_lshr_b32 s39, s37, 4
    s_lshl_b32 s38, s38, 20
    s_lshl_b32 s39, s39, 12
    s_add_u32 s38, s38, s39
    s_add_u32 s38, s38, s10
    s_add_u32 s38, s38, 917504
    s_cmp_lt_u32 s37, 512
    s_cselect_b32 s56, s38, 2147418112
    s_cselect_b32 s47, 2, 3
    s_cselect_b32 s45, s45, 0
    s_xor_b32 s57, s56, 0
RD_p1:
    s_branch P_loop
K_done:
    v_add_f32_dpp v165, v11, v11 quad_perm:[2,3,0,1] row_mask:0xf bank_mask:0xf
    v_mov_b32 v164, v10
    s_nop 1
    v_add_f32_dpp v165, v165, v165 row_ror:4 row_mask:0xf bank_mask:0xf
    s_nop 1
    v_add_f32_dpp v165, v165, v165 row_ror:8 row_mask:0xf bank_mask:0xf
    v_mov_b32_dpp v10, v164 row_newbcast:0 row_mask:0xf bank_mask:0xf
    v_mov_b32_dpp v11, v164 row_newbcast:1 row_mask:0xf bank_mask:0xf
    v_mov_b32_dpp v12, v165 row_newbcast:0 row_mask:0xf bank_mask:0xf
    v_mov_b32_dpp v13, v165 row_newbcast:1 row_mask:0xf bank_mask:0xf
    v_lshrrev_b32 v40, 4, v0
    v_and_b32 v41, 15, v1
    v_lshlrev_b32 v42, 10, v40
    v_lshl_add_u32 v42, v41, 5, v42
    v_add_u32 v42, 65536, v42
    ds_write_b128 v42, v[14:17]
    ds_write_b128 v42, v[18:21] offset:16
    ds_write_b128 v42, v[22:25] offset:512
    ds_write_b128 v42, v[26:29] offset:528
    v_lshlrev_b32 v43, 2, v40
    v_add_u32 v43, 81920, v43
    ds_write_b32 v43, v10
    ds_write_b32 v43, v11 offset:256
    ds_write_b32 v43, v12 offset:512
    ds_write_b32 v43, v13 offset:768
    s_lshr_b32 s31, s26, 1
    s_and_b32 s32, s26, 1
    s_lshl_b32 s33, s31, 8
    s_add_u32 s33, s33, 81920
    v_lshl_add_u32 v56, v41, 2, s33
    s_lshl_b32 s33, s26, 8
    s_add_u32 s33, s33, 65536
    v_lshl_add_u32 v57, v1, 2, s33
    s_lshl_b32 s33, s24, 1
    s_add_u32 s33, s33, s31
    s_lshl_b32 s34, s33, 13
    s_lshl_b32 s35, s32, 12
    s_add_u32 s34, s34, s35
    s_lshl_b32 s35, s25, 6
    s_add_u32 s34, s34, s35
    s_add_u32 s34, s34, 524288
    v_lshrrev_b32 v58, 4, v1
    v_lshlrev_b32 v58, 10, v58
    v_lshl_add_u32 v58, v41, 2, v58
    s_lshl_b32 s35, s24, 2
    s_add_u32 s35, s35, s26
    s_lshl_b32 s35, s35, 6
    s_add_u32 s35, s35, s25
    s_lshl_b32 s35, s35, 3
    s_add_u32 s35, s35, 786432
    v_lshlrev_b32 v59, 3, v1
    s_mov_b32 s36, 0x00010001
    s_mov_b32 s37, 0x00010001
    v_mov_b32 v7, 0
    s_waitcnt lgkmcnt(0)
    s_barrier
    ds_read_b32 v44, v56
    ds_read_b32 v45, v56 offset:512
    ds_read2st64_b32 v[128:129], v57 offset0:0 offset1:4
    ds_read2st64_b32 v[130:131], v57 offset0:8 offset1:12
    ds_read2st64_b32 v[132:133], v57 offset0:16 offset1:20
    ds_read2st64_b32 v[134:135], v57 offset0:24 offset1:28
    ds_read2st64_b32 v[136:137], v57 offset0:32 offset1:36
    ds_read2st64_b32 v[138:139], v57 offset0:40 offset1:44
    ds_read2st64_b32 v[140:141], v57 offset0:48 offset1:52
    ds_read2st64_b32 v[142:143], v57 offset0:56 offset1:60
    s_waitcnt lgkmcnt(9)
    v_max_f32_dpp v47, v44, v44 quad_perm:[1,0,3,2] row_mask:0xf bank_mask:0xf
    s_nop 1
    v_max_f32_dpp v47, v47, v47 quad_perm:[2,3,0,1] row_mask:0xf bank_mask:0xf
    s_nop 1
    v_max_f32_dpp v47, v47, v47 row_half_mirror row_mask:0xf bank_mask:0xf
    s_nop 1
    v_max_f32_dpp v47, v47, v47 row_mirror row_mask:0xf bank_mask:0xf
    v_sub_f32 v44, v44, v47
    v_mul_f32 v44, s30, v44
    v_exp_f32 v44, v44
    v_mov_b32 v50, v47
    s_waitcnt lgkmcnt(0)
    v_mul_f32 v51, v44, v45
    v_mul_f32_dpp v49, v44, v128 row_newbcast:0 row_mask:0xf bank_mask:0xf
    v_mul_f32_dpp v48, v44, v129 row_newbcast:1 row_mask:0xf bank_mask:0xf
    v_add_f32_dpp v51, v51, v51 quad_perm:[1,0,3,2] row_mask:0xf bank_mask:0xf
    v_fmac_f32_dpp v49, v44, v130 row_newbcast:2 row_mask:0xf bank_mask:0xf
    v_fmac_f32_dpp v48, v44, v131 row_newbcast:3 row_mask:0xf bank_mask:0xf
    v_add_f32_dpp v51, v51, v51 quad_perm:[2,3,0,1] row_mask:0xf bank_mask:0xf
    v_fmac_f32_dpp v49, v44, v132 row_newbcast:4 row_mask:0xf bank_mask:0xf
    v_fmac_f32_dpp v48, v44, v133 row_newbcast:5 row_mask:0xf bank_mask:0xf
    v_add_f32_dpp v51, v51, v51 row_half_mirror row_mask:0xf bank_mask:0xf
    v_fmac_f32_dpp v49, v44, v134 row_newbcast:6 row_mask:0xf bank_mask:0xf
    v_fmac_f32_dpp v48, v44, v135 row_newbcast:7 row_mask:0xf bank_mask:0xf
    v_add_f32_dpp v51, v51, v51 row_mirror row_mask:0xf bank_mask:0xf
    v_fmac_f32_dpp v49, v44, v136 row_newbcast:8 row_mask:0xf bank_mask:0xf
    v_fmac_f32_dpp v48, v44, v137 row_newbcast:9 row_mask:0xf bank_mask:0xf
    v_fmac_f32_dpp v49, v44, v138 row_newbcast:10 row_mask:0xf bank_mask:0xf
    v_fmac_f32_dpp v48, v44, v139 row_newbcast:11 row_mask:0xf bank_mask:0xf
    v_fmac_f32_dpp v49, v44, v140 row_newbcast:12 row_mask:0xf bank_mask:0xf
    v_fmac_f32_dpp v48, v44, v141 row_newbcast:13 row_mask:0xf bank_mask:0xf
    v_fmac_f32_dpp v49, v44, v142 row_newbcast:14 row_mask:0xf bank_mask:0xf
    v_fmac_f32_dpp v48, v44, v143 row_newbcast:15 row_mask:0xf bank_mask:0xf
    v_add_f32 v49, v49, v48
    buffer_store_dword v49, v58, s[20:23], s34 offen sc0 sc1
    s_mov_b64 exec, s[36:37]
    buffer_store_dwordx2 v[50:51], v59, s[20:23], s35 offen sc0 sc1
    s_mov_b64 exec, -1
    s_branch K_noml
    s_branch K_tail
K_wts:
    s_sub_u32 s31, s26, 5
    s_cmp_lg_u32 s25, 0
    s_cbranch_scc1 K_noinit
    s_cmp_gt_u32 s31, 0
    s_cbranch_scc1 K_noinit
    v_mov_b32 v40, -1
    v_mov_b32 v41, -1
    v_mov_b32 v42, -1
    v_mov_b32 v43, -1
    v_mov_b32 v44, 0
    v_mov_b32 v45, 0
    v_mov_b32 v46, 0
    v_mov_b32 v47, 0
    s_lshl_b32 s32, s24, 12
    s_mul_i32 s33, s24, 1024
    s_add_u32 s33, s33, 73728
    buffer_load_dword v48, off, s[4:7], 0 offset:192
    buffer_store_dwordx4 v[40:43], v38, s[20:23], s32 offen offset:0 sc0 sc1
    buffer_store_dwordx4 v[40:43], v38, s[20:23], s32 offen offset:1024 sc0 sc1
    buffer_store_dwordx4 v[40:43], v38, s[20:23], s32 offen offset:2048 sc0 sc1
    buffer_store_dwordx4 v[40:43], v38, s[20:23], s32 offen offset:3072 sc0 sc1
    buffer_store_dwordx4 v[44:47], v38, s[20:23], s33 offen sc0 sc1
    s_mul_i32 s33, s24, 5120
    s_add_u32 s33, s33, 90112
    s_and_b32 s3, s24, 3
    s_lshl_b32 s3, s3, 6
    s_and_b32 s32, s24, 12
    s_or_b32 s32, s32, s3
    v_mov_b32 v49, 1
    v_lshrrev_b32 v50, 5, v1
    v_mul_u32_u24 v50, 512, v50
    v_and_b32 v51, 31, v1
    v_lshl_add_u32 v50, v51, 4, v50
    s_waitcnt vmcnt(0)
    s_mov_b64 exec, 1
    buffer_store_dword v49, off, s[4:7], s32 sc0 sc1
    s_mov_b64 exec, -1
    buffer_store_dwordx4 v[44:47], v50, s[20:23], s33 offen sc0 sc1
    s_add_u32 s33, s33, 1024
    buffer_store_dwordx4 v[44:47], v50, s[20:23], s33 offen sc0 sc1
    s_add_u32 s33, s33, 1024
    buffer_store_dwordx4 v[44:47], v50, s[20:23], s33 offen sc0 sc1
    s_add_u32 s33, s33, 1024
    buffer_store_dwordx4 v[44:47], v50, s[20:23], s33 offen sc0 sc1
    s_add_u32 s33, s33, 1024
    buffer_store_dwordx4 v[44:47], v50, s[20:23], s33 offen sc0 sc1
    s_add_u32 s33, s33, 1024
    s_lshl_b32 s33, s24, 14
    s_add_u32 s33, s33, 524288
    buffer_store_dwordx4 v[40:43], v38, s[20:23], s33 offen offset:0 sc0 sc1
    buffer_store_dwordx4 v[40:43], v38, s[20:23], s33 offen offset:1024 sc0 sc1
    buffer_store_dwordx4 v[40:43], v38, s[20:23], s33 offen offset:2048 sc0 sc1
    buffer_store_dwordx4 v[40:43], v38, s[20:23], s33 offen offset:3072 sc0 sc1
    s_add_u32 s33, s33, 4096
    buffer_store_dwordx4 v[40:43], v38, s[20:23], s33 offen offset:0 sc0 sc1
    buffer_store_dwordx4 v[40:43], v38, s[20:23], s33 offen offset:1024 sc0 sc1
    buffer_store_dwordx4 v[40:43], v38, s[20:23], s33 offen offset:2048 sc0 sc1
    buffer_store_dwordx4 v[40:43], v38, s[20:23], s33 offen offset:3072 sc0 sc1
    s_add_u32 s33, s33, 4096
    buffer_store_dwordx4 v[40:43], v38, s[20:23], s33 offen offset:0 sc0 sc1
    buffer_store_dwordx4 v[40:43], v38, s[20:23], s33 offen offset:1024 sc0 sc1
    buffer_store_dwordx4 v[40:43], v38, s[20:23], s33 offen offset:2048 sc0 sc1
    buffer_store_dwordx4 v[40:43], v38, s[20:23], s33 offen offset:3072 sc0 sc1
    s_add_u32 s33, s33, 4096
    buffer_store_dwordx4 v[40:43], v38, s[20:23], s33 offen offset:0 sc0 sc1
    buffer_store_dwordx4 v[40:43], v38, s[20:23], s33 offen offset:1024 sc0 sc1
    buffer_store_dwordx4 v[40:43], v38, s[20:23], s33 offen offset:2048 sc0 sc1
    buffer_store_dwordx4 v[40:43], v38, s[20:23], s33 offen offset:3072 sc0 sc1
    s_add_u32 s33, s33, 4096
    s_lshl_b32 s33, s24, 11
    s_add_u32 s33, s33, 786432
    buffer_store_dwordx4 v[40:43], v38, s[20:23], s33 offen sc0 sc1
    buffer_store_dwordx4 v[40:43], v38, s[20:23], s33 offen offset:1024 sc0 sc1
    s_waitcnt vmcnt(0)
    s_mov_b64 exec, 1
    buffer_store_dword v49, off, s[4:7], s32 offset:16 sc0 sc1
    s_mov_b64 exec, -1
K_noinit:
    s_cmp_lg_u32 s31, 0
    s_cbranch_scc1 K_wwait
K_srv:
    s_mul_i32 s11, s24, 1024
    s_add_u32 s11, s11, 73728
    s_mov_b32 s43, 0
    s_mov_b32 s54, 4
    s_mov_b32 s40, 0
    s_mov_b32 s41, 0
    s_mov_b32 s42, 0
    s_mov_b32 s39, 0
    s_mov_b32 s52, 210
    v_lshlrev_b32 v43, 2, v1
    v_add_u32 v43, 16384, v43
    s_mov_b32 s44, 0
    s_mov_b32 s45, 0
K_sidle:
    ds_read_b32 v40, v160
    s_waitcnt lgkmcnt(0)
    v_readfirstlane_b32 s36, v40
    s_nop 3
    s_cmp_ge_u32 s36, 210
    s_cbranch_scc1 K_sloop
    s_sleep 16
    s_add_u32 s39, s39, 1
    s_cmp_lt_u32 s39, 2097152
    s_cbranch_scc1 K_sidle
K_sloop:
    ds_read_b32 v40, v160
    s_cmp_eq_u32 s44, 0
    s_cbranch_scc1 K_sk0
    s_cmp_eq_u32 s45, 0
    s_cbranch_scc1 K_sw00
    s_waitcnt vmcnt(1)
    s_branch K_sw10
K_sw00:
    s_waitcnt vmcnt(0)
K_sw10:
    v_readfirstlane_b32 s36, v64
    s_lshl_b32 s38, s40, 2
    v_add_u32 v42, s38, v43
    s_nop 2
    s_min_u32 s36, s36, 512
    s_sub_u32 s38, 512, s36
    s_min_u32 s38, s38, s44
    s_add_u32 s36, s36, s43
    v_add_u32 v41, s36, v1
    s_bfm_b64 exec, s38, 0
    ds_write_b32 v42, v41
    s_mov_b64 exec, -1
    s_add_u32 s40, s40, s38
    s_sub_u32 s41, s41, s44
    s_cmp_lt_u32 s38, s44
    s_cselect_b32 s42, 1, s42
    s_mov_b32 s44, 0
    ds_read_b32 v40, v160
K_sk0:
    s_waitcnt lgkmcnt(0)
    v_readfirstlane_b32 s36, v40
    s_add_u32 s37, s40, s41
    s_add_u32 s37, s37, s52
    s_cmp_lg_u32 s42, 0
    s_cbranch_scc1 K_sx0
    s_cmp_le_u32 s36, s37
    s_cbranch_scc1 K_si0
    s_sub_u32 s38, s36, s37
    s_max_u32 s38, s38, 4
    s_min_u32 s38, s38, 4
    s_mov_b32 s44, s38
    s_add_u32 s41, s41, s38
    v_mov_b32 v64, s38
    s_mov_b64 exec, 1
    buffer_atomic_add v64, off, s[20:23], s11 sc0 sc1 nt
    s_mov_b64 exec, -1
    s_branch K_sn0
K_sx0:
    s_cmp_eq_u32 s41, 0
    s_cbranch_scc1 K_sdone
    s_branch K_sn0
K_si0:
    s_cmp_lg_u32 s41, 0
    s_cbranch_scc1 K_sn0
    s_sleep 2
K_sn0:
    ds_read_b32 v40, v160
    s_cmp_eq_u32 s45, 0
    s_cbranch_scc1 K_sk1
    s_cmp_eq_u32 s44, 0
    s_cbranch_scc1 K_sw01
    s_waitcnt vmcnt(1)
    s_branch K_sw11
K_sw01:
    s_waitcnt vmcnt(0)
K_sw11:
    v_readfirstlane_b32 s36, v65
    s_lshl_b32 s38, s40, 2
    v_add_u32 v42, s38, v43
    s_nop 2
    s_min_u32 s36, s36, 512
    s_sub_u32 s38, 512, s36
    s_min_u32 s38, s38, s45
    s_add_u32 s36, s36, s43
    v_add_u32 v41, s36, v1
    s_bfm_b64 exec, s38, 0
    ds_write_b32 v42, v41
    s_mov_b64 exec, -1
    s_add_u32 s40, s40, s38
    s_sub_u32 s41, s41, s45
    s_cmp_lt_u32 s38, s45
    s_cselect_b32 s42, 1, s42
    s_mov_b32 s45, 0
    ds_read_b32 v40, v160
K_sk1:
    s_waitcnt lgkmcnt(0)
    v_readfirstlane_b32 s36, v40
    s_add_u32 s37, s40, s41
    s_add_u32 s37, s37, s52
    s_cmp_lg_u32 s42, 0
    s_cbranch_scc1 K_sx1
    s_cmp_le_u32 s36, s37
    s_cbranch_scc1 K_si1
    s_sub_u32 s38, s36, s37
    s_max_u32 s38, s38, 4
    s_min_u32 s38, s38, 4
    s_mov_b32 s45, s38
    s_add_u32 s41, s41, s38
    v_mov_b32 v65, s38
    s_mov_b64 exec, 1
    buffer_atomic_add v65, off, s[20:23], s11 sc0 sc1 nt
    s_mov_b64 exec, -1
    s_branch K_sn1
K_sx1:
    s_cmp_eq_u32 s41, 0
    s_cbranch_scc1 K_sdone
    s_branch K_sn1
K_si1:
    s_cmp_lg_u32 s41, 0
    s_cbranch_scc1 K_sn1
    s_sleep 2
K_sn1:
    s_add_u32 s39, s39, 1
    s_cmp_lt_u32 s39, 2097152
    s_cbranch_scc1 K_sloop
    s_waitcnt vmcnt(0)
K_sdone:
    s_lshl_b32 s38, s40, 2
    v_add_u32 v42, s38, v43
    v_mov_b32 v41, 2147483647
    ds_write_b32 v42, v41
    s_add_u32 s38, s40, 227
    s_mov_b32 s39, 0
K_strig:
    ds_read_b32 v40, v160
    s_add_u32 s39, s39, 1
    s_waitcnt lgkmcnt(0)
    v_readfirstlane_b32 s36, v40
    s_nop 3
    s_cmp_ge_u32 s36, s38
    s_cbranch_scc1 K_strig1
    s_sleep 2
    s_cmp_lt_u32 s39, 2097152
    s_cbranch_scc1 K_strig
K_strig1:
    v_mov_b32 v40, 1
    s_mov_b64 exec, 1
    buffer_atomic_add v40, off, s[4:7], 0 offset:96 sc0 sc1 nt
    s_waitcnt vmcnt(0)
    v_add_u32 v40, 1, v40
    ds_write_b32 v160, v40 offset:24
    s_mov_b64 exec, -1
    s_branch K_wwait
K_helper:
    v_lshlrev_b32 v40, 1, v1
    buffer_load_ushort v14, v40, s[68:71], 0 offen offset:0
    buffer_load_ushort v15, v40, s[68:71], 0 offen offset:128
    buffer_load_ushort v16, v40, s[68:71], 0 offen offset:256
    buffer_load_ushort v17, v40, s[68:71], 0 offen offset:384
    buffer_load_ushort v18, v40, s[68:71], 0 offen offset:512
    buffer_load_ushort v19, v40, s[68:71], 0 offen offset:640
    buffer_load_ushort v20, v40, s[68:71], 0 offen offset:768
    buffer_load_ushort v21, v40, s[68:71], 0 offen offset:896
    buffer_load_ushort v22, v40, s[68:71], 0 offen offset:1024
    v_lshrrev_b32 v41, 3, v1
    v_mul_u32_u24 v40, 147456, v41
    v_and_b32 v42, 7, v1
    v_lshl_add_u32 v40, v42, 4, v40
    s_lshr_b32 s33, s25, 2
    s_and_b32 s34, s25, 3
    s_mul_i32 s32, s33, 1179648
    s_lshl_b32 s35, s24, 9
    s_add_u32 s32, s32, s35
    s_lshl_b32 s35, s34, 7
    s_add_u32 s32, s32, s35
    buffer_load_dwordx4 v[64:67], v40, s[72:75], s32 offen nt
    s_add_u32 s32, s32, 8192
    buffer_load_dwordx4 v[68:71], v40, s[72:75], s32 offen nt
    s_add_u32 s32, s32, 8192
    buffer_load_dwordx4 v[72:75], v40, s[72:75], s32 offen nt
    s_add_u32 s32, s32, 8192
    buffer_load_dwordx4 v[76:79], v40, s[72:75], s32 offen nt
    s_add_u32 s32, s32, 8192
    buffer_load_dwordx4 v[80:83], v40, s[72:75], s32 offen nt
    s_add_u32 s32, s32, 8192
    buffer_load_dwordx4 v[84:87], v40, s[72:75], s32 offen nt
    s_add_u32 s32, s32, 8192
    buffer_load_dwordx4 v[88:91], v40, s[72:75], s32 offen nt
    s_add_u32 s32, s32, 8192
    buffer_load_dwordx4 v[92:95], v40, s[72:75], s32 offen nt
    s_add_u32 s32, s32, 8192
    buffer_load_dwordx4 v[96:99], v40, s[72:75], s32 offen nt
    s_add_u32 s32, s32, 8192
    buffer_load_dwordx4 v[100:103], v40, s[72:75], s32 offen nt
    s_add_u32 s32, s32, 8192
    buffer_load_dwordx4 v[104:107], v40, s[72:75], s32 offen nt
    s_add_u32 s32, s32, 8192
    buffer_load_dwordx4 v[108:111], v40, s[72:75], s32 offen nt
    s_add_u32 s32, s32, 8192
    buffer_load_dwordx4 v[112:115], v40, s[72:75], s32 offen nt
    s_add_u32 s32, s32, 8192
    buffer_load_dwordx4 v[116:119], v40, s[72:75], s32 offen nt
    s_add_u32 s32, s32, 8192
    buffer_load_dwordx4 v[120:123], v40, s[72:75], s32 offen nt
    s_add_u32 s32, s32, 8192
    buffer_load_dwordx4 v[124:127], v40, s[72:75], s32 offen nt
    s_add_u32 s32, s32, 8192
    buffer_load_dwordx4 v[128:131], v40, s[72:75], s32 offen nt
    s_add_u32 s32, s32, 8192
    buffer_load_dwordx4 v[132:135], v40, s[72:75], s32 offen nt
    v_mul_u32_u24 v34, 72, v41
    s_mul_i32 s35, s33, 576
    s_add_u32 s35, s35, 62848
    v_add_u32 v34, s35, v34
    s_and_b32 s3, s24, 3
    s_lshl_b32 s3, s3, 6
    s_and_b32 s66, s24, 12
    s_or_b32 s66, s66, s3
    buffer_load_dword v37, off, s[4:7], 0 offset:192
    s_waitcnt vmcnt(19)
    v_lshlrev_b32 v14, 16, v14
    v_lshlrev_b32 v15, 16, v15
    v_lshlrev_b32 v16, 16, v16
    v_lshlrev_b32 v17, 16, v17
    v_lshlrev_b32 v18, 16, v18
    v_lshlrev_b32 v19, 16, v19
    v_lshlrev_b32 v20, 16, v20
    v_lshlrev_b32 v21, 16, v21
    v_lshlrev_b32 v22, 16, v22
    v_add_f32 v23, v14, v15
    v_add_f32 v23, v23, v16
    v_add_f32 v23, v23, v17
    v_add_f32 v23, v23, v18
    v_add_f32 v23, v23, v19
    v_add_f32 v23, v23, v20
    v_add_f32 v23, v23, v21
    v_add_f32 v23, v23, v22
    s_nop 1
    v_add_f32_dpp v23, v23, v23 quad_perm:[1,0,3,2] row_mask:0xf bank_mask:0xf
    s_nop 1
    v_add_f32_dpp v23, v23, v23 quad_perm:[2,3,0,1] row_mask:0xf bank_mask:0xf
    s_nop 1
    v_add_f32_dpp v23, v23, v23 row_half_mirror row_mask:0xf bank_mask:0xf
    s_nop 1
    v_add_f32_dpp v23, v23, v23 row_mirror row_mask:0xf bank_mask:0xf
    s_nop 1
    v_add_f32_dpp v23, v23, v23 row_bcast:15 row_mask:0xa bank_mask:0xf
    s_nop 1
    v_add_f32_dpp v23, v23, v23 row_bcast:31 row_mask:0xc bank_mask:0xf
    s_nop 1
    v_readlane_b32 s36, v23, 63
    s_nop 3
    v_mov_b32 v24, s36
    v_mov_b32 v25, 0x44100000
    v_rcp_f32 v26, v25
    s_nop 0
    v_mul_f32 v23, v24, v26
    v_fma_f32 v27, -v23, v25, v24
    v_fma_f32 v23, v27, v26, v23
    v_sub_f32 v24, v14, v23
    v_mul_f32 v25, v24, v24
    v_sub_f32 v24, v15, v23
    v_fmac_f32 v25, v24, v24
    v_sub_f32 v24, v16, v23
    v_fmac_f32 v25, v24, v24
    v_sub_f32 v24, v17, v23
    v_fmac_f32 v25, v24, v24
    v_sub_f32 v24, v18, v23
    v_fmac_f32 v25, v24, v24
    v_sub_f32 v24, v19, v23
    v_fmac_f32 v25, v24, v24
    v_sub_f32 v24, v20, v23
    v_fmac_f32 v25, v24, v24
    v_sub_f32 v24, v21, v23
    v_fmac_f32 v25, v24, v24
    v_sub_f32 v24, v22, v23
    v_fmac_f32 v25, v24, v24
    s_nop 1
    v_add_f32_dpp v25, v25, v25 quad_perm:[1,0,3,2] row_mask:0xf bank_mask:0xf
    s_nop 1
    v_add_f32_dpp v25, v25, v25 quad_perm:[2,3,0,1] row_mask:0xf bank_mask:0xf
    s_nop 1
    v_add_f32_dpp v25, v25, v25 row_half_mirror row_mask:0xf bank_mask:0xf
    s_nop 1
    v_add_f32_dpp v25, v25, v25 row_mirror row_mask:0xf bank_mask:0xf
    s_nop 1
    v_add_f32_dpp v25, v25, v25 row_bcast:15 row_mask:0xa bank_mask:0xf
    s_nop 1
    v_add_f32_dpp v25, v25, v25 row_bcast:31 row_mask:0xc bank_mask:0xf
    s_nop 1
    v_readlane_b32 s36, v25, 63
    s_nop 3
    v_mov_b32 v25, s36
    v_mov_b32 v26, 0x44100000
    v_rcp_f32 v27, v26
    s_nop 0
    v_mul_f32 v24, v25, v27
    v_fma_f32 v28, -v24, v26, v25
    v_fma_f32 v24, v28, v27, v24
    v_cvt_pk_bf16_f32 v24, v24, v24
    v_lshlrev_b32 v24, 16, v24
    v_add_f32 v24, 0x3727c5ac, v24
    v_cvt_pk_bf16_f32 v24, v24, v24
    v_lshlrev_b32 v24, 16, v24
    v_sqrt_f32 v24, v24
    s_nop 0
    v_cvt_pk_bf16_f32 v24, v24, v24
    v_lshlrev_b32 v24, 16, v24
    v_cvt_pk_bf16_f32 v23, v23, v23
    v_lshlrev_b32 v23, 16, v23
    v_sub_f32 v25, v14, v23
    v_cvt_pk_bf16_f32 v25, v25, v25
    v_lshlrev_b32 v25, 16, v25
    v_rcp_f32 v26, v24
    s_nop 0
    v_mul_f32 v14, v25, v26
    v_fma_f32 v27, -v14, v24, v25
    v_fma_f32 v14, v27, v26, v14
    v_cvt_pk_bf16_f32 v14, v14, v14
    v_lshlrev_b32 v14, 16, v14
    v_sub_f32 v25, v15, v23
    v_cvt_pk_bf16_f32 v25, v25, v25
    v_lshlrev_b32 v25, 16, v25
    v_rcp_f32 v26, v24
    s_nop 0
    v_mul_f32 v15, v25, v26
    v_fma_f32 v27, -v15, v24, v25
    v_fma_f32 v15, v27, v26, v15
    v_cvt_pk_bf16_f32 v15, v15, v15
    v_lshlrev_b32 v15, 16, v15
    v_sub_f32 v25, v16, v23
    v_cvt_pk_bf16_f32 v25, v25, v25
    v_lshlrev_b32 v25, 16, v25
    v_rcp_f32 v26, v24
    s_nop 0
    v_mul_f32 v16, v25, v26
    v_fma_f32 v27, -v16, v24, v25
    v_fma_f32 v16, v27, v26, v16
    v_cvt_pk_bf16_f32 v16, v16, v16
    v_lshlrev_b32 v16, 16, v16
    v_sub_f32 v25, v17, v23
    v_cvt_pk_bf16_f32 v25, v25, v25
    v_lshlrev_b32 v25, 16, v25
    v_rcp_f32 v26, v24
    s_nop 0
    v_mul_f32 v17, v25, v26
    v_fma_f32 v27, -v17, v24, v25
    v_fma_f32 v17, v27, v26, v17
    v_cvt_pk_bf16_f32 v17, v17, v17
    v_lshlrev_b32 v17, 16, v17
    v_sub_f32 v25, v18, v23
    v_cvt_pk_bf16_f32 v25, v25, v25
    v_lshlrev_b32 v25, 16, v25
    v_rcp_f32 v26, v24
    s_nop 0
    v_mul_f32 v18, v25, v26
    v_fma_f32 v27, -v18, v24, v25
    v_fma_f32 v18, v27, v26, v18
    v_cvt_pk_bf16_f32 v18, v18, v18
    v_lshlrev_b32 v18, 16, v18
    v_sub_f32 v25, v19, v23
    v_cvt_pk_bf16_f32 v25, v25, v25
    v_lshlrev_b32 v25, 16, v25
    v_rcp_f32 v26, v24
    s_nop 0
    v_mul_f32 v19, v25, v26
    v_fma_f32 v27, -v19, v24, v25
    v_fma_f32 v19, v27, v26, v19
    v_cvt_pk_bf16_f32 v19, v19, v19
    v_lshlrev_b32 v19, 16, v19
    v_sub_f32 v25, v20, v23
    v_cvt_pk_bf16_f32 v25, v25, v25
    v_lshlrev_b32 v25, 16, v25
    v_rcp_f32 v26, v24
    s_nop 0
    v_mul_f32 v20, v25, v26
    v_fma_f32 v27, -v20, v24, v25
    v_fma_f32 v20, v27, v26, v20
    v_cvt_pk_bf16_f32 v20, v20, v20
    v_lshlrev_b32 v20, 16, v20
    v_sub_f32 v25, v21, v23
    v_cvt_pk_bf16_f32 v25, v25, v25
    v_lshlrev_b32 v25, 16, v25
    v_rcp_f32 v26, v24
    s_nop 0
    v_mul_f32 v21, v25, v26
    v_fma_f32 v27, -v21, v24, v25
    v_fma_f32 v21, v27, v26, v21
    v_cvt_pk_bf16_f32 v21, v21, v21
    v_lshlrev_b32 v21, 16, v21
    v_sub_f32 v25, v22, v23
    v_cvt_pk_bf16_f32 v25, v25, v25
    v_lshlrev_b32 v25, 16, v25
    v_rcp_f32 v26, v24
    s_nop 0
    v_mul_f32 v22, v25, v26
    v_fma_f32 v27, -v22, v24, v25
    v_fma_f32 v22, v27, v26, v22
    v_cvt_pk_bf16_f32 v22, v22, v22
    v_lshlrev_b32 v22, 16, v22
    v_lshlrev_b32 v40, 2, v1
    ds_write_b32 v40, v14 offset:62848
    ds_write_b32 v40, v15 offset:63104
    ds_write_b32 v40, v16 offset:63360
    ds_write_b32 v40, v17 offset:63616
    ds_write_b32 v40, v18 offset:63872
    ds_write_b32 v40, v19 offset:64128
    ds_write_b32 v40, v20 offset:64384
    ds_write_b32 v40, v21 offset:64640
    ds_write_b32 v40, v22 offset:64896
    s_waitcnt lgkmcnt(0)
    ds_read_b64 v[40:41], v34 offset:0
    ds_read_b64 v[42:43], v34 offset:8
    ds_read_b64 v[44:45], v34 offset:16
    ds_read_b64 v[46:47], v34 offset:24
    ds_read_b64 v[48:49], v34 offset:32
    ds_read_b64 v[50:51], v34 offset:40
    ds_read_b64 v[52:53], v34 offset:48
    ds_read_b64 v[54:55], v34 offset:56
    ds_read_b64 v[56:57], v34 offset:64
    v_mov_b32 v2, 0
    v_mov_b32 v3, 0
    v_mov_b32 v4, 0
    v_mov_b32 v5, 0
    v_mov_b32 v6, 0
    v_mov_b32 v7, 0
    v_mov_b32 v8, 0
    v_mov_b32 v9, 0
    s_waitcnt lgkmcnt(0)
    s_waitcnt vmcnt(18)
    v_lshlrev_b32 v10, 16, v64
    v_and_b32 v11, 0xffff0000, v64
    v_fmac_f32 v2, v40, v10
    v_fmac_f32 v3, v40, v11
    v_lshlrev_b32 v12, 16, v65
    v_and_b32 v13, 0xffff0000, v65
    v_fmac_f32 v4, v40, v12
    v_fmac_f32 v5, v40, v13
    v_lshlrev_b32 v10, 16, v66
    v_and_b32 v11, 0xffff0000, v66
    v_fmac_f32 v6, v40, v10
    v_fmac_f32 v7, v40, v11
    v_lshlrev_b32 v12, 16, v67
    v_and_b32 v13, 0xffff0000, v67
    v_fmac_f32 v8, v40, v12
    v_fmac_f32 v9, v40, v13
    s_waitcnt vmcnt(17)
    v_lshlrev_b32 v10, 16, v68
    v_and_b32 v11, 0xffff0000, v68
    v_fmac_f32 v2, v41, v10
    v_fmac_f32 v3, v41, v11
    v_lshlrev_b32 v12, 16, v69
    v_and_b32 v13, 0xffff0000, v69
    v_fmac_f32 v4, v41, v12
    v_fmac_f32 v5, v41, v13
    v_lshlrev_b32 v10, 16, v70
    v_and_b32 v11, 0xffff0000, v70
    v_fmac_f32 v6, v41, v10
    v_fmac_f32 v7, v41, v11
    v_lshlrev_b32 v12, 16, v71
    v_and_b32 v13, 0xffff0000, v71
    v_fmac_f32 v8, v41, v12
    v_fmac_f32 v9, v41, v13
    s_waitcnt vmcnt(16)
    v_lshlrev_b32 v10, 16, v72
    v_and_b32 v11, 0xffff0000, v72
    v_fmac_f32 v2, v42, v10
    v_fmac_f32 v3, v42, v11
    v_lshlrev_b32 v12, 16, v73
    v_and_b32 v13, 0xffff0000, v73
    v_fmac_f32 v4, v42, v12
    v_fmac_f32 v5, v42, v13
    v_lshlrev_b32 v10, 16, v74
    v_and_b32 v11, 0xffff0000, v74
    v_fmac_f32 v6, v42, v10
    v_fmac_f32 v7, v42, v11
    v_lshlrev_b32 v12, 16, v75
    v_and_b32 v13, 0xffff0000, v75
    v_fmac_f32 v8, v42, v12
    v_fmac_f32 v9, v42, v13
    s_waitcnt vmcnt(15)
    v_lshlrev_b32 v10, 16, v76
    v_and_b32 v11, 0xffff0000, v76
    v_fmac_f32 v2, v43, v10
    v_fmac_f32 v3, v43, v11
    v_lshlrev_b32 v12, 16, v77
    v_and_b32 v13, 0xffff0000, v77
    v_fmac_f32 v4, v43, v12
    v_fmac_f32 v5, v43, v13
    v_lshlrev_b32 v10, 16, v78
    v_and_b32 v11, 0xffff0000, v78
    v_fmac_f32 v6, v43, v10
    v_fmac_f32 v7, v43, v11
    v_lshlrev_b32 v12, 16, v79
    v_and_b32 v13, 0xffff0000, v79
    v_fmac_f32 v8, v43, v12
    v_fmac_f32 v9, v43, v13
    s_waitcnt vmcnt(14)
    v_lshlrev_b32 v10, 16, v80
    v_and_b32 v11, 0xffff0000, v80
    v_fmac_f32 v2, v44, v10
    v_fmac_f32 v3, v44, v11
    v_lshlrev_b32 v12, 16, v81
    v_and_b32 v13, 0xffff0000, v81
    v_fmac_f32 v4, v44, v12
    v_fmac_f32 v5, v44, v13
    v_lshlrev_b32 v10, 16, v82
    v_and_b32 v11, 0xffff0000, v82
    v_fmac_f32 v6, v44, v10
    v_fmac_f32 v7, v44, v11
    v_lshlrev_b32 v12, 16, v83
    v_and_b32 v13, 0xffff0000, v83
    v_fmac_f32 v8, v44, v12
    v_fmac_f32 v9, v44, v13
    s_waitcnt vmcnt(13)
    v_lshlrev_b32 v10, 16, v84
    v_and_b32 v11, 0xffff0000, v84
    v_fmac_f32 v2, v45, v10
    v_fmac_f32 v3, v45, v11
    v_lshlrev_b32 v12, 16, v85
    v_and_b32 v13, 0xffff0000, v85
    v_fmac_f32 v4, v45, v12
    v_fmac_f32 v5, v45, v13
    v_lshlrev_b32 v10, 16, v86
    v_and_b32 v11, 0xffff0000, v86
    v_fmac_f32 v6, v45, v10
    v_fmac_f32 v7, v45, v11
    v_lshlrev_b32 v12, 16, v87
    v_and_b32 v13, 0xffff0000, v87
    v_fmac_f32 v8, v45, v12
    v_fmac_f32 v9, v45, v13
    s_waitcnt vmcnt(12)
    v_lshlrev_b32 v10, 16, v88
    v_and_b32 v11, 0xffff0000, v88
    v_fmac_f32 v2, v46, v10
    v_fmac_f32 v3, v46, v11
    v_lshlrev_b32 v12, 16, v89
    v_and_b32 v13, 0xffff0000, v89
    v_fmac_f32 v4, v46, v12
    v_fmac_f32 v5, v46, v13
    v_lshlrev_b32 v10, 16, v90
    v_and_b32 v11, 0xffff0000, v90
    v_fmac_f32 v6, v46, v10
    v_fmac_f32 v7, v46, v11
    v_lshlrev_b32 v12, 16, v91
    v_and_b32 v13, 0xffff0000, v91
    v_fmac_f32 v8, v46, v12
    v_fmac_f32 v9, v46, v13
    s_waitcnt vmcnt(11)
    v_lshlrev_b32 v10, 16, v92
    v_and_b32 v11, 0xffff0000, v92
    v_fmac_f32 v2, v47, v10
    v_fmac_f32 v3, v47, v11
    v_lshlrev_b32 v12, 16, v93
    v_and_b32 v13, 0xffff0000, v93
    v_fmac_f32 v4, v47, v12
    v_fmac_f32 v5, v47, v13
    v_lshlrev_b32 v10, 16, v94
    v_and_b32 v11, 0xffff0000, v94
    v_fmac_f32 v6, v47, v10
    v_fmac_f32 v7, v47, v11
    v_lshlrev_b32 v12, 16, v95
    v_and_b32 v13, 0xffff0000, v95
    v_fmac_f32 v8, v47, v12
    v_fmac_f32 v9, v47, v13
    s_waitcnt vmcnt(10)
    v_lshlrev_b32 v10, 16, v96
    v_and_b32 v11, 0xffff0000, v96
    v_fmac_f32 v2, v48, v10
    v_fmac_f32 v3, v48, v11
    v_lshlrev_b32 v12, 16, v97
    v_and_b32 v13, 0xffff0000, v97
    v_fmac_f32 v4, v48, v12
    v_fmac_f32 v5, v48, v13
    v_lshlrev_b32 v10, 16, v98
    v_and_b32 v11, 0xffff0000, v98
    v_fmac_f32 v6, v48, v10
    v_fmac_f32 v7, v48, v11
    v_lshlrev_b32 v12, 16, v99
    v_and_b32 v13, 0xffff0000, v99
    v_fmac_f32 v8, v48, v12
    v_fmac_f32 v9, v48, v13
    s_waitcnt vmcnt(9)
    v_lshlrev_b32 v10, 16, v100
    v_and_b32 v11, 0xffff0000, v100
    v_fmac_f32 v2, v49, v10
    v_fmac_f32 v3, v49, v11
    v_lshlrev_b32 v12, 16, v101
    v_and_b32 v13, 0xffff0000, v101
    v_fmac_f32 v4, v49, v12
    v_fmac_f32 v5, v49, v13
    v_lshlrev_b32 v10, 16, v102
    v_and_b32 v11, 0xffff0000, v102
    v_fmac_f32 v6, v49, v10
    v_fmac_f32 v7, v49, v11
    v_lshlrev_b32 v12, 16, v103
    v_and_b32 v13, 0xffff0000, v103
    v_fmac_f32 v8, v49, v12
    v_fmac_f32 v9, v49, v13
    s_waitcnt vmcnt(8)
    v_lshlrev_b32 v10, 16, v104
    v_and_b32 v11, 0xffff0000, v104
    v_fmac_f32 v2, v50, v10
    v_fmac_f32 v3, v50, v11
    v_lshlrev_b32 v12, 16, v105
    v_and_b32 v13, 0xffff0000, v105
    v_fmac_f32 v4, v50, v12
    v_fmac_f32 v5, v50, v13
    v_lshlrev_b32 v10, 16, v106
    v_and_b32 v11, 0xffff0000, v106
    v_fmac_f32 v6, v50, v10
    v_fmac_f32 v7, v50, v11
    v_lshlrev_b32 v12, 16, v107
    v_and_b32 v13, 0xffff0000, v107
    v_fmac_f32 v8, v50, v12
    v_fmac_f32 v9, v50, v13
    s_waitcnt vmcnt(7)
    v_lshlrev_b32 v10, 16, v108
    v_and_b32 v11, 0xffff0000, v108
    v_fmac_f32 v2, v51, v10
    v_fmac_f32 v3, v51, v11
    v_lshlrev_b32 v12, 16, v109
    v_and_b32 v13, 0xffff0000, v109
    v_fmac_f32 v4, v51, v12
    v_fmac_f32 v5, v51, v13
    v_lshlrev_b32 v10, 16, v110
    v_and_b32 v11, 0xffff0000, v110
    v_fmac_f32 v6, v51, v10
    v_fmac_f32 v7, v51, v11
    v_lshlrev_b32 v12, 16, v111
    v_and_b32 v13, 0xffff0000, v111
    v_fmac_f32 v8, v51, v12
    v_fmac_f32 v9, v51, v13
    s_waitcnt vmcnt(6)
    v_lshlrev_b32 v10, 16, v112
    v_and_b32 v11, 0xffff0000, v112
    v_fmac_f32 v2, v52, v10
    v_fmac_f32 v3, v52, v11
    v_lshlrev_b32 v12, 16, v113
    v_and_b32 v13, 0xffff0000, v113
    v_fmac_f32 v4, v52, v12
    v_fmac_f32 v5, v52, v13
    v_lshlrev_b32 v10, 16, v114
    v_and_b32 v11, 0xffff0000, v114
    v_fmac_f32 v6, v52, v10
    v_fmac_f32 v7, v52, v11
    v_lshlrev_b32 v12, 16, v115
    v_and_b32 v13, 0xffff0000, v115
    v_fmac_f32 v8, v52, v12
    v_fmac_f32 v9, v52, v13
    s_waitcnt vmcnt(5)
    v_lshlrev_b32 v10, 16, v116
    v_and_b32 v11, 0xffff0000, v116
    v_fmac_f32 v2, v53, v10
    v_fmac_f32 v3, v53, v11
    v_lshlrev_b32 v12, 16, v117
    v_and_b32 v13, 0xffff0000, v117
    v_fmac_f32 v4, v53, v12
    v_fmac_f32 v5, v53, v13
    v_lshlrev_b32 v10, 16, v118
    v_and_b32 v11, 0xffff0000, v118
    v_fmac_f32 v6, v53, v10
    v_fmac_f32 v7, v53, v11
    v_lshlrev_b32 v12, 16, v119
    v_and_b32 v13, 0xffff0000, v119
    v_fmac_f32 v8, v53, v12
    v_fmac_f32 v9, v53, v13
    s_waitcnt vmcnt(4)
    v_lshlrev_b32 v10, 16, v120
    v_and_b32 v11, 0xffff0000, v120
    v_fmac_f32 v2, v54, v10
    v_fmac_f32 v3, v54, v11
    v_lshlrev_b32 v12, 16, v121
    v_and_b32 v13, 0xffff0000, v121
    v_fmac_f32 v4, v54, v12
    v_fmac_f32 v5, v54, v13
    v_lshlrev_b32 v10, 16, v122
    v_and_b32 v11, 0xffff0000, v122
    v_fmac_f32 v6, v54, v10
    v_fmac_f32 v7, v54, v11
    v_lshlrev_b32 v12, 16, v123
    v_and_b32 v13, 0xffff0000, v123
    v_fmac_f32 v8, v54, v12
    v_fmac_f32 v9, v54, v13
    s_waitcnt vmcnt(3)
    v_lshlrev_b32 v10, 16, v124
    v_and_b32 v11, 0xffff0000, v124
    v_fmac_f32 v2, v55, v10
    v_fmac_f32 v3, v55, v11
    v_lshlrev_b32 v12, 16, v125
    v_and_b32 v13, 0xffff0000, v125
    v_fmac_f32 v4, v55, v12
    v_fmac_f32 v5, v55, v13
    v_lshlrev_b32 v10, 16, v126
    v_and_b32 v11, 0xffff0000, v126
    v_fmac_f32 v6, v55, v10
    v_fmac_f32 v7, v55, v11
    v_lshlrev_b32 v12, 16, v127
    v_and_b32 v13, 0xffff0000, v127
    v_fmac_f32 v8, v55, v12
    v_fmac_f32 v9, v55, v13
    s_waitcnt vmcnt(2)
    v_lshlrev_b32 v10, 16, v128
    v_and_b32 v11, 0xffff0000, v128
    v_fmac_f32 v2, v56, v10
    v_fmac_f32 v3, v56, v11
    v_lshlrev_b32 v12, 16, v129
    v_and_b32 v13, 0xffff0000, v129
    v_fmac_f32 v4, v56, v12
    v_fmac_f32 v5, v56, v13
    v_lshlrev_b32 v10, 16, v130
    v_and_b32 v11, 0xffff0000, v130
    v_fmac_f32 v6, v56, v10
    v_fmac_f32 v7, v56, v11
    v_lshlrev_b32 v12, 16, v131
    v_and_b32 v13, 0xffff0000, v131
    v_fmac_f32 v8, v56, v12
    v_fmac_f32 v9, v56, v13
    s_waitcnt vmcnt(1)
    v_lshlrev_b32 v10, 16, v132
    v_and_b32 v11, 0xffff0000, v132
    v_fmac_f32 v2, v57, v10
    v_fmac_f32 v3, v57, v11
    v_lshlrev_b32 v12, 16, v133
    v_and_b32 v13, 0xffff0000, v133
    v_fmac_f32 v4, v57, v12
    v_fmac_f32 v5, v57, v13
    v_lshlrev_b32 v10, 16, v134
    v_and_b32 v11, 0xffff0000, v134
    v_fmac_f32 v6, v57, v10
    v_fmac_f32 v7, v57, v11
    v_lshlrev_b32 v12, 16, v135
    v_and_b32 v13, 0xffff0000, v135
    v_fmac_f32 v8, v57, v12
    v_fmac_f32 v9, v57, v13
    s_nop 1
    v_permlane32_swap_b32 v2, v6
    v_permlane32_swap_b32 v3, v7
    v_permlane32_swap_b32 v4, v8
    v_permlane32_swap_b32 v5, v9
    s_nop 1
    v_add_f32 v2, v2, v6
    v_add_f32 v3, v3, v7
    v_add_f32 v4, v4, v8
    v_add_f32 v5, v5, v9
    s_nop 1
    v_permlane16_swap_b32 v2, v4
    v_permlane16_swap_b32 v3, v5
    s_nop 1
    v_add_f32 v2, v2, v4
    v_add_f32 v3, v3, v5
    s_nop 1
    v_add_f32_dpp v2, v2, v2 row_ror:8 row_mask:0xf bank_mask:0xf
    v_add_f32_dpp v3, v3, v3 row_ror:8 row_mask:0xf bank_mask:0xf
    v_and_b32 v40, 7, v1
    v_lshlrev_b32 v40, 3, v40
    v_lshrrev_b32 v41, 4, v1
    v_lshl_add_u32 v40, v41, 6, v40
    v_and_b32 v43, 8, v1
    s_lshl_b32 s32, s24, 12
    s_lshl_b32 s35, s33, 10
    s_add_u32 s35, s35, s32
    s_lshl_b32 s34, s34, 8
    s_add_u32 s35, s35, s34
    s_mov_b32 s39, 0
    v_cmp_eq_u32 s[50:51], 0, v43
    s_and_b32 s34, s25, 3
    s_lshl_b32 s34, s34, 4
    s_mov_b64 exec, s[50:51]
    buffer_store_dwordx2 v[2:3], v40, s[20:23], s35 offen offset:0 sc0 sc1
    s_mov_b64 exec, -1
    buffer_load_dword v36, off, s[4:7], s66 sc0 sc1
    v_lshlrev_b32 v33, 7, v41
    v_and_b32 v34, 3, v1
    v_lshl_add_u32 v33, v34, 5, v33
    v_and_b32 v34, 12, v1
    v_add3_u32 v33, v33, v34, v160
K_oflag:
    s_waitcnt vmcnt(0)
    v_readfirstlane_b32 s36, v36
    s_add_u32 s39, s39, 1
    s_nop 3
    s_cmp_lg_u32 s36, 0
    s_cbranch_scc1 K_opoll
    s_cmp_ge_u32 s39, 2097152
    s_cbranch_scc1 K_opoll
    s_sleep 3
    buffer_load_dword v36, off, s[4:7], s66 sc0 sc1
    s_branch K_oflag
K_ore:
    s_mov_b64 exec, s[50:51]
    buffer_store_dwordx2 v[2:3], v40, s[20:23], s35 offen offset:0 sc0 sc1
    s_mov_b64 exec, -1
    s_waitcnt vmcnt(0)
K_opoll:
    buffer_load_dwordx4 v[44:47], v38, s[20:23], s32 offen offset:0 sc0 sc1
    buffer_load_dwordx4 v[48:51], v38, s[20:23], s32 offen offset:1024 sc0 sc1
    buffer_load_dwordx4 v[52:55], v38, s[20:23], s32 offen offset:2048 sc0 sc1
    buffer_load_dwordx4 v[56:59], v38, s[20:23], s32 offen offset:3072 sc0 sc1
    s_waitcnt vmcnt(0)
    v_max3_u32 v60, v44, v45, v46
    v_max3_u32 v61, v48, v49, v50
    v_max3_u32 v62, v52, v53, v54
    v_max3_u32 v63, v56, v57, v58
    v_max_u32 v60, v60, v47
    v_max_u32 v61, v61, v51
    v_max_u32 v62, v62, v55
    v_max_u32 v63, v63, v59
    v_cmp_eq_u32 s[40:41], -1, v60
    v_cmp_eq_u32 s[42:43], -1, v61
    v_cmp_eq_u32 s[44:45], -1, v62
    v_cmp_eq_u32 s[46:47], -1, v63
    s_add_u32 s39, s39, 1
    s_nop 2
    s_or_b64 s[36:37], s[40:41], s[42:43]
    s_or_b64 s[48:49], s[44:45], s[46:47]
    s_or_b64 s[36:37], s[36:37], s[48:49]
    s_cbranch_scc0 K_qok0
    s_cmp_ge_u32 s39, 2097152
    s_cbranch_scc1 K_qok0
    s_cmp_eq_u32 s33, 1
    s_cselect_b64 s[40:41], s[42:43], s[40:41]
    s_cmp_eq_u32 s33, 2
    s_cselect_b64 s[40:41], s[44:45], s[40:41]
    s_cmp_eq_u32 s33, 3
    s_cselect_b64 s[40:41], s[46:47], s[40:41]
    s_lshr_b64 s[40:41], s[40:41], s34
    s_and_b32 s40, s40, 0xffff
    s_cbranch_scc1 K_ore
    s_sleep 1
    s_branch K_opoll
K_flagchk:
    s_waitcnt vmcnt(0)
    v_readfirstlane_b32 s36, v36
    s_add_u32 s39, s39, 1
    s_nop 3
    s_cmp_lg_u32 s36, 0
    s_cbranch_scc1 K_flagok
    s_cmp_ge_u32 s39, 2097152
    s_cbranch_scc1 K_flagok
    s_sleep 3
    buffer_load_dword v36, off, s[4:7], s66 sc0 sc1
    s_branch K_flagchk
K_flagok:
    v_cmp_eq_u32 vcc, 0, v43
    s_and_saveexec_b64 s[36:37], vcc
    buffer_store_dwordx2 v[2:3], v40, s[20:23], s35 offen offset:0 sc0 sc1
    s_mov_b64 exec, -1
    s_mov_b32 s39, 0
K_qpoll:
    buffer_load_dwordx4 v[44:47], v38, s[20:23], s32 offen offset:0 sc0 sc1
    buffer_load_dwordx4 v[48:51], v38, s[20:23], s32 offen offset:1024 sc0 sc1
    buffer_load_dwordx4 v[52:55], v38, s[20:23], s32 offen offset:2048 sc0 sc1
    buffer_load_dwordx4 v[56:59], v38, s[20:23], s32 offen offset:3072 sc0 sc1
    s_waitcnt vmcnt(0)
    v_max3_u32 v60, v44, v45, v46
    v_max3_u32 v60, v60, v47, v48
    v_max3_u32 v60, v60, v49, v50
    v_max3_u32 v60, v60, v51, v52
    v_max3_u32 v60, v60, v53, v54
    v_max3_u32 v60, v60, v55, v56
    v_max3_u32 v60, v60, v57, v58
    v_max_u32 v60, v60, v59
    v_cmp_ne_u32 vcc, -1, v60
    s_add_u32 s39, s39, 1
    s_nop 3
    s_cmp_eq_u64 vcc, exec
    s_cbranch_scc1 K_qok0
    s_cmp_ge_u32 s39, 2097152
    s_cbranch_scc1 K_qok0
    s_sleep 1
    s_branch K_qpoll
K_qok0:
    v_add_f32 v20, v44, v48
    v_add_f32 v24, v52, v56
    v_add_f32 v21, v45, v49
    v_add_f32 v25, v53, v57
    v_add_f32 v22, v46, v50
    v_add_f32 v26, v54, v58
    v_add_f32 v23, v47, v51
    v_add_f32 v27, v55, v59
K_qok:
    v_add_f32 v20, v20, v24
    v_add_f32 v21, v21, v25
    v_add_f32 v22, v22, v26
    v_add_f32 v23, v23, v27
    v_cvt_pk_bf16_f32 v40, v20, v21
    v_cvt_pk_bf16_f32 v41, v22, v23
    v_lshlrev_b32 v42, 3, v1
    v_mov_b32 v43, 1
    v_subrev_u32 v33, 512, v33
    ds_write2_b32 v33, v40, v41 offset0:0 offset1:4
    s_waitcnt lgkmcnt(0)
    ds_write_b32 v160, v43 offset:16
    v_lshlrev_b32 v42, 2, v1
    s_mov_b32 s39, 0
    v_and_b32 v42, 3, v1
    v_lshlrev_b32 v42, 6, v42
    v_and_b32 v43, 12, v1
    v_or_b32 v42, v42, v43
    s_and_b32 s37, s2, 63
    s_add_u32 s37, s37, 120
K_fbw:
    ds_read_b32 v44, v160
    s_add_u32 s39, s39, 1
    s_waitcnt lgkmcnt(0)
    v_readfirstlane_b32 s36, v44
    s_nop 3
    s_cmp_ge_u32 s36, s37
    s_cbranch_scc1 K_fbw1
    s_sleep 16
    s_cmp_lt_u32 s39, 2097152
    s_cbranch_scc1 K_fbw
K_fbw1:
    s_mov_b32 s39, 0
    s_mov_b64 exec, 0xffff
K_fbpoll:
    buffer_load_dword v44, v42, s[4:7], 0 offen offset:16 sc0 sc1
    s_waitcnt vmcnt(0)
    v_cmp_ne_u32 vcc, 0, v44
    s_add_u32 s39, s39, 1
    s_nop 3
    s_cmp_eq_u64 vcc, exec
    s_cbranch_scc1 K_fbok
    s_cmp_ge_u32 s39, 2097152
    s_cbranch_scc1 K_fbok
    s_sleep 32
    s_branch K_fbpoll
K_fbok:
    s_mov_b64 exec, -1
K_wwait:
    s_mov_b32 s39, 0
K_wwait1:
    ds_read_b32 v40, v160 offset:24
    s_add_u32 s39, s39, 1
    s_waitcnt lgkmcnt(0)
    v_readfirstlane_b32 s36, v40
    s_nop 3
    s_cmp_lg_u32 s36, 0
    s_cbranch_scc1 K_early
    s_sleep 8
    s_cmp_lt_u32 s39, 2097152
    s_cbranch_scc1 K_wwait1
K_early:
K_tail:
    s_setprio 0
    v_mov_b32 v7, 0
    s_waitcnt lgkmcnt(0)
    s_barrier
K_noml:
    ds_read_b32 v40, v160 offset:24
    s_waitcnt lgkmcnt(0)
    v_readfirstlane_b32 s36, v40
    s_nop 3
    s_sub_u32 s31, s36, 10
    s_sub_u32 s32, s31, 64
    s_cmp_ge_u32 s31, 0
    s_cselect_b32 s31, s32, s31
    s_mul_i32 s32, s31, 37
    s_lshr_b32 s32, s32, 8
    s_add_u32 s33, s31, s32
    s_and_b32 s32, s33, 7
    s_cmp_ge_u32 s32, 3
    s_addc_u32 s33, s33, 0
    s_cmp_lt_u32 s31, 63
    s_cselect_b32 s50, 2, 0
    s_lshl_b32 s32, s36, 3
    s_sub_u32 s32, s32, 5
    s_cmp_le_u32 s36, 9
    s_cselect_b32 s50, 2, s50
    s_cselect_b32 s31, s32, s33
    s_sub_u32 s51, s36, 10
    s_cmp_lt_u32 s51, 64
    s_cselect_b32 s50, 1, s50
    s_cselect_b32 s51, s51, s31
    s_cmp_eq_u32 s50, 0
    s_cbranch_scc1 RL_s_x
    v_lshrrev_b32 v40, 3, v1
    v_and_b32 v41, 7, v1
    v_lshlrev_b32 v41, 4, v41
    v_mul_u32_u24 v42, 9216, v40
    v_add_u32 v42, v42, v41
    s_lshl_b32 s33, s26, 7
    s_cmp_eq_u32 s50, 2
    s_cbranch_scc1 RL_s_2
    s_mul_i32 s32, s51, 73728
    s_add_u32 s32, s32, s33
    s_add_u32 s33, s32, 4608
    buffer_load_dwordx4 v[64:67], v42, s[76:79], s32 offen offset:0 nt
    buffer_load_dwordx4 v[68:71], v42, s[76:79], s32 offen offset:1152 nt
    buffer_load_dwordx4 v[72:75], v42, s[76:79], s32 offen offset:2304 nt
    buffer_load_dwordx4 v[76:79], v42, s[76:79], s32 offen offset:3456 nt
    buffer_load_dwordx4 v[80:83], v42, s[76:79], s33 offen offset:0 nt
    buffer_load_dwordx4 v[84:87], v42, s[76:79], s33 offen offset:1152 nt
    buffer_load_dwordx4 v[88:91], v42, s[76:79], s33 offen offset:2304 nt
    buffer_load_dwordx4 v[92:95], v42, s[76:79], s33 offen offset:3456 nt
    s_branch RL_s_x
RL_s_2:
    s_mul_i32 s32, s51, 73728
    s_add_u32 s32, s32, s33
    s_add_u32 s33, s32, 4608
    v_mul_u32_u24 v43, 18432, v40
    v_add_u32 v43, v43, v41
    s_mul_i32 s34, s26, 589824
    s_lshl_b32 s35, s51, 7
    s_add_u32 s34, s34, s35
    v_and_b32 v44, 3, v1
    v_lshlrev_b32 v44, 4, v44
    v_lshrrev_b32 v45, 2, v1
    v_add_u32 v151, v44, v45
    s_lshl_b32 s36, s26, 7
    v_lshlrev_b32 v44, 1, v151
    v_lshlrev_b32 v45, 1, v1
    buffer_load_dwordx4 v[64:67], v43, s[80:83], s34 offen nt
    s_add_u32 s34, s34, 147456
    buffer_load_dwordx4 v[68:71], v43, s[80:83], s34 offen nt
    s_add_u32 s34, s34, 147456
    buffer_load_dwordx4 v[72:75], v43, s[80:83], s34 offen nt
    s_add_u32 s34, s34, 147456
    buffer_load_dwordx4 v[76:79], v43, s[80:83], s34 offen nt
    s_sub_u32 s34, s34, 433152
    buffer_load_dwordx4 v[80:83], v43, s[80:83], s34 offen nt
    s_add_u32 s34, s34, 147456
    buffer_load_dwordx4 v[84:87], v43, s[80:83], s34 offen nt
    s_add_u32 s34, s34, 147456
    buffer_load_dwordx4 v[88:91], v43, s[80:83], s34 offen nt
    s_add_u32 s34, s34, 147456
    buffer_load_dwordx4 v[92:95], v43, s[80:83], s34 offen nt
    buffer_load_ushort v144, v44, s[68:71], s36 offen
    buffer_load_ushort v146, v44, s[92:95], s36 offen
    buffer_load_ushort v145, v45, s[88:91], s35 offen
    buffer_load_dwordx4 v[96:99], v42, s[84:87], s32 offen offset:0 nt
    buffer_load_dwordx4 v[100:103], v42, s[84:87], s32 offen offset:1152 nt
    buffer_load_dwordx4 v[104:107], v42, s[84:87], s32 offen offset:2304 nt
    buffer_load_dwordx4 v[108:111], v42, s[84:87], s32 offen offset:3456 nt
    buffer_load_dwordx4 v[112:115], v42, s[84:87], s33 offen offset:0 nt
    buffer_load_dwordx4 v[116:119], v42, s[84:87], s33 offen offset:1152 nt
    buffer_load_dwordx4 v[120:123], v42, s[84:87], s33 offen offset:2304 nt
    buffer_load_dwordx4 v[124:127], v42, s[84:87], s33 offen offset:3456 nt
RL_s_x:
K_nocomb:
    s_cmp_eq_u32 s50, 0
    s_cbranch_scc1 K_fin
    s_mov_b32 s46, 0x05040100
    s_mov_b32 s47, 0x07060302
    v_and_b32 v40, 7, v1
    v_lshlrev_b32 v40, 3, v40
    v_lshrrev_b32 v41, 5, v1
    v_lshl_or_b32 v40, v41, 2, v40
    v_bfe_u32 v41, v1, 4, 1
    v_lshl_or_b32 v40, v41, 1, v40
    v_bfe_u32 v41, v1, 3, 1
    v_or_b32 v40, v40, v41
    s_lshl_b32 s33, s26, 8
    v_lshlrev_b32 v149, 2, v40
    v_add_u32 v149, s33, v149
    s_mul_i32 s33, s26, 512
    v_lshlrev_b32 v148, 3, v1
    v_add_u32 v148, s33, v148
    v_lshrrev_b32 v35, 3, v1
    v_lshlrev_b32 v35, 4, v35
    s_cmp_eq_u32 s50, 2
    s_cbranch_scc1 K_ffn
    s_waitcnt vmcnt(0)
    v_perm_b32 v96, v68, v64, s46
    v_perm_b32 v100, v68, v64, s47
    v_perm_b32 v104, v69, v65, s46
    v_perm_b32 v108, v69, v65, s47
    v_perm_b32 v97, v76, v72, s46
    v_perm_b32 v101, v76, v72, s47
    v_perm_b32 v105, v77, v73, s46
    v_perm_b32 v109, v77, v73, s47
    v_perm_b32 v98, v84, v80, s46
    v_perm_b32 v102, v84, v80, s47
    v_perm_b32 v106, v85, v81, s46
    v_perm_b32 v110, v85, v81, s47
    v_perm_b32 v99, v92, v88, s46
    v_perm_b32 v103, v92, v88, s47
    v_perm_b32 v107, v93, v89, s46
    v_perm_b32 v111, v93, v89, s47
    v_perm_b32 v64, v70, v66, s46
    v_perm_b32 v68, v70, v66, s47
    v_perm_b32 v72, v71, v67, s46
    v_perm_b32 v76, v71, v67, s47
    v_perm_b32 v65, v78, v74, s46
    v_perm_b32 v69, v78, v74, s47
    v_perm_b32 v73, v79, v75, s46
    v_perm_b32 v77, v79, v75, s47
    v_perm_b32 v66, v86, v82, s46
    v_perm_b32 v70, v86, v82, s47
    v_perm_b32 v74, v87, v83, s46
    v_perm_b32 v78, v87, v83, s47
    v_perm_b32 v67, v94, v90, s46
    v_perm_b32 v71, v94, v90, s47
    v_perm_b32 v75, v95, v91, s46
    v_perm_b32 v79, v95, v91, s47
    s_and_b32 s33, s51, 3
    s_mul_i32 s48, s33, 4608
    s_add_u32 s48, s48, 90112
    s_sub_u32 s31, s26, 4
    s_cmp_ge_u32 s31, 4
    s_cbranch_scc1 K_noo16
    s_lshr_b32 s33, s51, 1
    s_lshl_b32 s32, s33, 7
    s_add_u32 s32, s32, 65536
    v_lshrrev_b32 v40, 2, v1
    v_lshlrev_b32 v40, 3, v40
    s_lshl_b32 s33, s51, 2
    s_add_u32 s33, s33, s31
    s_lshl_b32 s32, s33, 7
    s_add_u32 s32, s32, 786432
    s_lshl_b32 s33, s33, 10
    s_add_u32 s33, s33, 524288
    s_lshl_b32 s34, s31, 5
    s_add_u32 s34, s34, 61248
    v_and_b32 v41, 3, v1
    v_lshlrev_b32 v41, 3, v41
    v_lshrrev_b32 v42, 4, v1
    v_lshl_add_u32 v41, v42, 1, v41
    v_add_u32 v41, s34, v41
    s_mov_b32 s39, 0
    buffer_load_dwordx2 v[44:45], v40, s[20:23], s32 offen sc0 sc1
    buffer_load_dwordx4 v[48:51], v38, s[20:23], s33 offen sc0 sc1
K_poll1:
    s_waitcnt vmcnt(0)
    v_max3_u32 v52, v44, v45, v48
    v_max3_u32 v52, v52, v49, v50
    v_max_u32 v52, v52, v51
    v_cmp_ne_u32 vcc, -1, v52
    s_nop 3
    s_andn2_b64 exec, exec, vcc
    s_cbranch_scc0 K_poll1_f0
    s_sleep 1
    buffer_load_dwordx2 v[44:45], v40, s[20:23], s32 offen sc0 sc1
    buffer_load_dwordx4 v[48:51], v38, s[20:23], s33 offen sc0 sc1
    s_add_u32 s39, s39, 1
    s_cmp_lt_u32 s39, 2097152
    s_cbranch_scc1 K_poll1
    s_waitcnt vmcnt(0)
K_poll1_f0:
K_poll1_d:
    s_mov_b64 exec, -1
    s_nop 0
    v_max_f32_dpp v47, v44, v44 row_ror:4 row_mask:0xf bank_mask:0xf
    s_nop 1
    v_max_f32_dpp v47, v47, v47 row_ror:8 row_mask:0xf bank_mask:0xf
    s_nop 1
    v_max_f32_dpp v47, v47, v47 row_bcast:15 row_mask:0xa bank_mask:0xf
    s_nop 1
    v_max_f32_dpp v47, v47, v47 row_bcast:31 row_mask:0xc bank_mask:0xf
    s_nop 1
    v_readlane_b32 s36, v47, 63
    s_nop 3
    v_subrev_f32 v47, s36, v44
    v_mul_f32 v47, s30, v47
    v_exp_f32 v47, v47
    s_nop 0
    v_mul_f32 v52, v47, v45
    v_mul_f32 v48, v48, v47
    v_mul_f32 v49, v49, v47
    v_mul_f32 v50, v50, v47
    v_mul_f32 v51, v51, v47
    v_mov_b32 v53, v52
    s_nop 0
    v_permlane32_swap_b32 v48, v50
    v_permlane32_swap_b32 v49, v51
    v_permlane32_swap_b32 v52, v53
    v_add_f32 v48, v48, v50
    v_add_f32 v49, v49, v51
    v_add_f32 v52, v52, v53
    v_mov_b32 v53, v52
    v_permlane16_swap_b32 v48, v49
    s_nop 0
    v_permlane16_swap_b32 v52, v53
    v_add_f32 v48, v48, v49
    v_add_f32 v52, v52, v53
    s_nop 0
    v_add_f32_dpp v48, v48, v48 row_ror:4 row_mask:0xf bank_mask:0xf
    v_add_f32_dpp v52, v52, v52 row_ror:4 row_mask:0xf bank_mask:0xf
    s_nop 0
    v_add_f32_dpp v48, v48, v48 row_ror:8 row_mask:0xf bank_mask:0xf
    v_add_f32_dpp v52, v52, v52 row_ror:8 row_mask:0xf bank_mask:0xf
    v_rcp_f32 v57, v52
    s_mov_b32 exec_lo, 0x000f000f
    s_mov_b32 exec_hi, 0x000f000f
    v_mul_f32 v53, v48, v57
    v_fma_f32 v58, -v53, v52, v48
    v_fma_f32 v53, v58, v57, v53
    v_cvt_pk_bf16_f32 v53, v53, v53
    ds_write_b16 v41, v53
    s_mov_b64 exec, -1
K_noo16:
    s_waitcnt lgkmcnt(0)
    s_barrier
    ds_read_b128 v[10:13], v35 offset:61248
    s_waitcnt lgkmcnt(0)
    s_nop 1
    v_mfma_f32_16x16x32_bf16 v[112:115], v[10:13], v[96:99], 0
    v_mfma_f32_16x16x32_bf16 v[80:83], v[10:13], v[64:67], 0
    v_mfma_f32_16x16x32_bf16 v[116:119], v[10:13], v[100:103], 0
    v_mfma_f32_16x16x32_bf16 v[84:87], v[10:13], v[68:71], 0
    v_mfma_f32_16x16x32_bf16 v[120:123], v[10:13], v[104:107], 0
    v_permlane32_swap_b32 v112, v80
    v_mfma_f32_16x16x32_bf16 v[88:91], v[10:13], v[72:75], 0
    s_nop 0
    v_add_f32_dpp v2, v80, v112 row_ror:8 row_mask:0x5 bank_mask:0x3
    v_mfma_f32_16x16x32_bf16 v[124:127], v[10:13], v[108:111], 0
    v_permlane32_swap_b32 v116, v84
    v_mfma_f32_16x16x32_bf16 v[92:95], v[10:13], v[76:79], 0
    s_nop 0
    v_add_f32_dpp v2, v116, v84 row_ror:8 row_mask:0x5 bank_mask:0xc
    v_permlane32_swap_b32 v120, v88
    s_nop 1
    v_add_f32_dpp v2, v88, v120 row_ror:8 row_mask:0xa bank_mask:0x3
    s_nop 1
    v_permlane32_swap_b32 v124, v92
    s_nop 1
    v_add_f32_dpp v2, v124, v92 row_ror:8 row_mask:0xa bank_mask:0xc
    v_mul_f32 v59, 0x43800000, v2
    v_floor_f32 v9, v59
    v_sub_f32 v59, v59, v9
    v_cvt_i32_f32 v9, v9
    v_mul_f32 v59, 0x4f800000, v59
    v_cvt_u32_f32 v8, v59
    v_and_b32 v8, 0xfffffe00, v8
    v_or_b32 v8, 1, v8
    buffer_atomic_add_x2 v[8:9], v148, s[20:23], s48 offen
    s_add_u32 s48, s48, 18432
    buffer_atomic_add_x2 v[8:9], v148, s[20:23], s48 offen
    s_branch K_fin
K_ffn:
    v_lshrrev_b32 v40, 5, v1
    v_mul_u32_u24 v40, 4608, v40
    v_and_b32 v41, 31, v1
    v_lshl_add_u32 v40, v41, 4, v40
    v_add_u32 v150, s33, v40
    s_and_b32 s34, s51, 1
    s_mul_i32 s40, s34, 18432
    s_add_u32 s40, s40, 90112
    s_add_u32 s41, s40, 9216
    s_add_u32 s42, s40, 18432
    s_add_u32 s43, s40, 27648
    s_lshl_b32 s33, s26, 8
    s_add_u32 s33, s33, 12288
    v_lshlrev_b32 v36, 2, v151
    v_add_u32 v36, s33, v36
    s_lshl_b32 s33, s26, 7
    v_lshlrev_b32 v37, 1, v151
    v_add_u32 v37, s33, v37
    v_add_u32 v35, s33, v35
    v_lshlrev_b32 v34, 1, v1
    v_add_u32 v34, s33, v34
    v_lshlrev_b32 v33, 2, v1
    s_waitcnt vmcnt(8)
    v_perm_b32 v26, v68, v64, s46
    v_perm_b32 v4, v68, v64, s47
    v_perm_b32 v152, v69, v65, s46
    v_perm_b32 v156, v69, v65, s47
    v_perm_b32 v27, v76, v72, s46
    v_perm_b32 v5, v76, v72, s47
    v_perm_b32 v153, v77, v73, s46
    v_perm_b32 v157, v77, v73, s47
    v_perm_b32 v28, v84, v80, s46
    v_perm_b32 v6, v84, v80, s47
    v_perm_b32 v154, v85, v81, s46
    v_perm_b32 v158, v85, v81, s47
    v_perm_b32 v29, v92, v88, s46
    v_perm_b32 v7, v92, v88, s47
    v_perm_b32 v155, v93, v89, s46
    v_perm_b32 v159, v93, v89, s47
    v_perm_b32 v64, v70, v66, s46
    v_perm_b32 v68, v70, v66, s47
    v_perm_b32 v72, v71, v67, s46
    v_perm_b32 v76, v71, v67, s47
    v_perm_b32 v65, v78, v74, s46
    v_perm_b32 v69, v78, v74, s47
    v_perm_b32 v73, v79, v75, s46
    v_perm_b32 v77, v79, v75, s47
    v_perm_b32 v66, v86, v82, s46
    v_perm_b32 v70, v86, v82, s47
    v_perm_b32 v74, v87, v83, s46
    v_perm_b32 v78, v87, v83, s47
    v_perm_b32 v67, v94, v90, s46
    v_perm_b32 v71, v94, v90, s47
    v_perm_b32 v75, v95, v91, s46
    v_perm_b32 v79, v95, v91, s47
    v_mov_b32 v10, 0x3f803f80
    v_mov_b32 v11, 0x3f803f80
    v_mov_b32 v12, 0x3f803f80
    v_mov_b32 v13, 0x3f803f80
    s_nop 1
    v_mfma_f32_16x16x32_bf16 v[14:17], v[10:13], v[26:29], 0
    v_mfma_f32_16x16x32_bf16 v[46:49], v[10:13], v[64:67], 0
    v_mfma_f32_16x16x32_bf16 v[18:21], v[10:13], v[4:7], 0
    v_mfma_f32_16x16x32_bf16 v[50:53], v[10:13], v[68:71], 0
    v_mfma_f32_16x16x32_bf16 v[22:25], v[10:13], v[152:155], 0
    v_permlane32_swap_b32 v14, v46
    v_mfma_f32_16x16x32_bf16 v[54:57], v[10:13], v[72:75], 0
    s_nop 0
    v_add_f32_dpp v2, v46, v14 row_ror:8 row_mask:0x5 bank_mask:0x3
    v_mfma_f32_16x16x32_bf16 v[14:17], v[10:13], v[156:159], 0
    v_permlane32_swap_b32 v18, v50
    v_mfma_f32_16x16x32_bf16 v[46:49], v[10:13], v[76:79], 0
    s_nop 0
    v_add_f32_dpp v2, v18, v50 row_ror:8 row_mask:0x5 bank_mask:0xc
    v_permlane32_swap_b32 v22, v54
    s_nop 1
    v_add_f32_dpp v2, v54, v22 row_ror:8 row_mask:0xa bank_mask:0x3
    s_nop 1
    v_permlane32_swap_b32 v14, v46
    s_nop 1
    v_add_f32_dpp v2, v14, v46 row_ror:8 row_mask:0xa bank_mask:0xc
    v_add_u32 v35, 82944, v33
    v_add_u32 v36, 82944, v149
    ds_write_b32 v36, v2
    ds_read2st64_b32 v[14:15], v35 offset0:0 offset1:1
    ds_read2st64_b32 v[16:17], v35 offset0:2 offset1:3
    ds_read2st64_b32 v[18:19], v35 offset0:4 offset1:5
    ds_read2st64_b32 v[20:21], v35 offset0:6 offset1:7
    ds_read_b32 v22, v35 offset:2048
    s_lshl_b32 s33, s26, 4
    s_add_u32 s33, s33, 85248
    v_lshrrev_b32 v34, 5, v1
    v_lshlrev_b32 v34, 3, v34
    v_and_b32 v35, 4, v1
    v_add3_u32 v34, v34, v35, s33
    v_and_b32 v35, 15, v1
    v_lshlrev_b32 v35, 4, v35
    v_add_u32 v35, 85248, v35
    s_waitcnt lgkmcnt(0)
    v_max3_u32 v46, v14, v15, v16
    v_max3_u32 v47, v17, v18, v19
    v_max3_u32 v48, v20, v21, v22
    v_max3_u32 v46, v46, v47, v48
    v_cmp_eq_u32 vcc, -1, v46
    v_pk_add_f32 v[14:15], v[14:15], v[16:17]
    v_pk_add_f32 v[18:19], v[18:19], v[20:21]
    s_cbranch_vccnz K_nc
    v_pk_add_f32 v[14:15], v[14:15], v[18:19]
    v_add_f32 v14, v14, v15
    v_add_f32 v14, v14, v22
    ds_write_b32 v33, v14 offset:2304
K_nc:
    v_lshlrev_b32 v144, 16, v144
    v_lshlrev_b32 v145, 16, v145
    v_lshlrev_b32 v146, 16, v146
    s_mul_i32 s34, s51, 57
    s_lshr_b32 s34, s34, 9
    s_lshr_b32 s36, s34, 1
    s_mul_i32 s34, s34, 9
    s_sub_u32 s34, s51, s34
    s_sub_u32 s34, s34, s26
    s_mul_i32 s34, s34, 512
    s_mul_i32 s36, s36, 4608
    s_add_u32 s34, s34, s36
    v_add_u32 v41, s34, v150
    v_mov_b32 v42, 1
    s_mov_b32 s39, 0
    s_mov_b32 s49, 1
K_gw0:
    ds_read_b32 v40, v160 offset:28
    s_getreg_b32 s37, hwreg(HW_REG_IB_STS, 0, 4)
    s_add_u32 s39, s39, 1
    s_waitcnt lgkmcnt(0)
    v_readfirstlane_b32 s36, v40
    s_nop 3
    s_cmp_ge_u32 s36, 0x10000
    s_cbranch_scc1 K_gdone
    s_cmp_eq_u32 s37, 0
    s_cbranch_scc1 K_ga
    s_sleep 1
    s_cmp_lt_u32 s39, 100
    s_cbranch_scc1 K_gw0
K_ga:
    s_waitcnt vmcnt(0)
    s_mov_b64 exec, 1
    ds_add_rtn_u32 v40, v160, v42 offset:28
    s_mov_b64 exec, -1
    v_perm_b32 v80, v100, v96, s46
    v_perm_b32 v84, v100, v96, s47
    v_perm_b32 v88, v101, v97, s46
    v_perm_b32 v92, v101, v97, s47
    v_perm_b32 v81, v108, v104, s46
    v_perm_b32 v85, v108, v104, s47
    v_perm_b32 v89, v109, v105, s46
    v_perm_b32 v93, v109, v105, s47
    v_perm_b32 v82, v116, v112, s46
    v_perm_b32 v86, v116, v112, s47
    v_perm_b32 v90, v117, v113, s46
    v_perm_b32 v94, v117, v113, s47
    v_perm_b32 v83, v124, v120, s46
    v_perm_b32 v87, v124, v120, s47
    v_perm_b32 v91, v125, v121, s46
    v_perm_b32 v95, v125, v121, s47
    v_perm_b32 v96, v102, v98, s46
    v_perm_b32 v100, v102, v98, s47
    v_perm_b32 v104, v103, v99, s46
    v_perm_b32 v108, v103, v99, s47
    v_perm_b32 v97, v110, v106, s46
    v_perm_b32 v101, v110, v106, s47
    v_perm_b32 v105, v111, v107, s46
    v_perm_b32 v109, v111, v107, s47
    v_perm_b32 v98, v118, v114, s46
    v_perm_b32 v102, v118, v114, s47
    v_perm_b32 v106, v119, v115, s46
    v_perm_b32 v110, v119, v115, s47
    v_perm_b32 v99, v126, v122, s46
    v_perm_b32 v103, v126, v122, s47
    v_perm_b32 v107, v127, v123, s46
    v_perm_b32 v111, v127, v123, s47
    s_mov_b32 s49, 0
    s_mov_b32 s39, 0
    s_waitcnt lgkmcnt(0)
    v_readfirstlane_b32 s36, v40
    s_nop 3
    s_cmp_eq_u32 s36, 0
    s_cbranch_scc1 K_gate
K_gw:
    ds_read_b32 v40, v160 offset:28
    s_add_u32 s39, s39, 1
    s_waitcnt lgkmcnt(0)
    v_readfirstlane_b32 s36, v40
    s_nop 3
    s_cmp_ge_u32 s36, 0x10000
    s_cbranch_scc1 K_gdone
    s_sleep 1
    s_cmp_lt_u32 s39, 8388608
    s_cbranch_scc1 K_gw
    s_branch K_gdone
K_gate:
    s_mov_b32 exec_lo, 1
    s_mov_b32 exec_hi, 0
K_gate1:
    buffer_load_dword v128, v41, s[20:23], s40 offen sc0 sc1
    s_add_u32 s39, s39, 1
    s_waitcnt vmcnt(0)
    v_and_b32 v52, 0x1ff, v128
    s_nop 1
    v_readlane_b32 s36, v52, 0
    s_nop 3
    s_cmp_ge_u32 s36, 16
    s_cbranch_scc1 K_gate2
    s_sleep 1
    s_cmp_lt_u32 s39, 2097152
    s_cbranch_scc1 K_gate1
K_gate2:
    v_mov_b32 v40, 0x10000
    ds_or_b32 v160, v40 offset:28
    s_mov_b64 exec, -1
K_gdone:
    s_setprio 3
    s_mov_b32 s39, 0
    buffer_load_dwordx4 v[128:131], v150, s[20:23], s40 offen sc0 sc1
    buffer_load_dwordx4 v[132:135], v150, s[20:23], s41 offen sc0 sc1
K_cp1:
    s_waitcnt vmcnt(0)
    v_lshl_add_u64 v[128:129], v[128:129], 0, v[132:133]
    v_lshl_add_u64 v[130:131], v[130:131], 0, v[134:135]
    s_nop 1
    v_permlane32_swap_b32 v128, v130
    v_permlane32_swap_b32 v129, v131
    s_nop 0
    v_lshl_add_u64 v[52:53], v[128:129], 0, v[130:131]
    v_and_b32 v54, 0x1ff, v52
    v_cmp_eq_u32 vcc, 64, v54
    v_cvt_f32_u32 v52, v52
    v_cvt_f32_i32 v53, v53
    v_mul_f32 v44, 0x2b800000, v52
    v_fmac_f32 v44, 0x3b800000, v53
    s_nop 0
    s_cmp_eq_u64 vcc, exec
    s_cbranch_scc1 K_cp1_d
    s_sleep 1
    buffer_load_dwordx4 v[128:131], v150, s[20:23], s40 offen sc0 sc1
    buffer_load_dwordx4 v[132:135], v150, s[20:23], s41 offen sc0 sc1
    s_add_u32 s39, s39, 1
    s_cmp_lt_u32 s39, 2097152
    s_cbranch_scc1 K_cp1
    s_waitcnt vmcnt(0)
K_cp1_f0:
K_cp1_d:
    v_cvt_pk_bf16_f32 v44, v44, v44
    v_lshlrev_b32 v44, 16, v44
    v_add_f32 v45, v44, v144
    v_cvt_pk_bf16_f32 v147, v45, v45
    v_lshlrev_b32 v147, 16, v147
    v_mov_b32_dpp v60, v45 quad_perm:[1,1,3,3] row_mask:0xf bank_mask:0xf
    v_cvt_pk_bf16_f32 v60, v45, v60
    s_nop 1
    v_mov_b32_dpp v10, v60 quad_perm:[0,1,2,3] row_mask:0xf bank_mask:0x5
    v_mov_b32_dpp v11, v60 row_shl:2 row_mask:0xf bank_mask:0x5
    v_mov_b32_dpp v12, v60 row_shl:4 row_mask:0xf bank_mask:0x5
    v_mov_b32_dpp v13, v60 row_shl:6 row_mask:0xf bank_mask:0x5
    s_nop 1
    v_mfma_f32_16x16x32_bf16 v[162:165], v[10:13], v[10:13], 0
    v_mfma_f32_16x16x32_bf16 v[14:17], v[10:13], v[26:29], 0
    v_mfma_f32_16x16x32_bf16 v[46:49], v[10:13], v[64:67], 0
    s_mov_b32 exec_lo, 0x11
    s_mov_b32 exec_hi, 0x1100
    s_nop 1
    ds_write_b32 v34, v162
    s_mov_b64 exec, -1
    ds_read_b128 v[40:43], v35
    s_setprio 0
    v_mfma_f32_16x16x32_bf16 v[18:21], v[10:13], v[4:7], 0
    v_mfma_f32_16x16x32_bf16 v[50:53], v[10:13], v[68:71], 0
    v_mfma_f32_16x16x32_bf16 v[22:25], v[10:13], v[152:155], 0
    v_permlane32_swap_b32 v14, v46
    v_mfma_f32_16x16x32_bf16 v[54:57], v[10:13], v[72:75], 0
    s_nop 0
    v_add_f32_dpp v2, v46, v14 row_ror:8 row_mask:0xf bank_mask:0x3
    v_mfma_f32_16x16x32_bf16 v[14:17], v[10:13], v[156:159], 0
    v_permlane32_swap_b32 v18, v50
    v_mfma_f32_16x16x32_bf16 v[46:49], v[10:13], v[76:79], 0
    s_waitcnt lgkmcnt(0)
    v_add_f32_dpp v2, v18, v50 row_ror:8 row_mask:0xf bank_mask:0xc
    v_permlane32_swap_b32 v22, v54
    v_max3_u32 v60, v40, v41, v42
    v_max_u32 v60, v60, v43
    v_add_f32_dpp v3, v54, v22 row_ror:8 row_mask:0xf bank_mask:0x3
    v_pk_add_f32 v[40:41], v[40:41], v[42:43]
    v_cmp_eq_u32 vcc, -1, v60
    v_permlane32_swap_b32 v14, v46
    v_add_f32_dpp v40, v40, v40 quad_perm:[1,0,3,2] row_mask:0xf bank_mask:0xf
    v_add_f32_dpp v41, v41, v41 quad_perm:[1,0,3,2] row_mask:0xf bank_mask:0xf
    v_add_f32_dpp v3, v14, v46 row_ror:8 row_mask:0xf bank_mask:0xc
    v_add_f32_dpp v40, v40, v40 quad_perm:[2,3,0,1] row_mask:0xf bank_mask:0xf
    v_add_f32_dpp v41, v41, v41 quad_perm:[2,3,0,1] row_mask:0xf bank_mask:0xf
    v_permlane16_swap_b32 v2, v3
    v_add_f32_dpp v40, v40, v40 row_half_mirror row_mask:0xf bank_mask:0xf
    v_add_f32_dpp v41, v41, v41 row_half_mirror row_mask:0xf bank_mask:0xf
    ds_write_b32 v149, v2 offset:0
    s_cbranch_vccnz K_ns
    v_add_f32_dpp v40, v40, v40 row_mirror row_mask:0xf bank_mask:0xf
    v_add_f32_dpp v41, v41, v41 row_mirror row_mask:0xf bank_mask:0xf
    v_mul_f32 v14, 0x3ae38e39, v41
    v_mul_f32 v15, 0x3ae38e39, v40
    v_fma_f32 v15, -v14, v14, v15
    v_cvt_pk_bf16_f32 v14, v15, v14
    v_lshlrev_b32 v15, 16, v14
    v_add_f32 v15, 0x3727c5ac, v15
    v_cvt_pk_bf16_f32 v15, v15, v15
    v_lshlrev_b32 v15, 16, v15
    v_sqrt_f32 v15, v15
    v_and_b32 v14, 0xffff0000, v14
    v_cvt_pk_bf16_f32 v15, v15, v15
    v_lshlrev_b32 v15, 16, v15
    v_rcp_f32 v15, v15
    s_nop 0
    ds_write2st64_b32 v33, v14, v15 offset0:10 offset1:11
K_ns:
    s_and_b32 s34, s51, 7
    s_mul_i32 s48, s34, 4608
    s_add_u32 s48, s48, 126976
    s_mov_b32 s40, 126976
    s_mov_b32 s41, 136192
    s_mov_b32 s42, 145408
    s_mov_b32 s43, 154624
    s_cmp_eq_u32 s49, 0
    s_cbranch_scc1 K_np
    v_perm_b32 v80, v100, v96, s46
    v_perm_b32 v84, v100, v96, s47
    v_perm_b32 v88, v101, v97, s46
    v_perm_b32 v92, v101, v97, s47
    v_perm_b32 v81, v108, v104, s46
    v_perm_b32 v85, v108, v104, s47
    v_perm_b32 v89, v109, v105, s46
    v_perm_b32 v93, v109, v105, s47
    v_perm_b32 v82, v116, v112, s46
    v_perm_b32 v86, v116, v112, s47
    v_perm_b32 v90, v117, v113, s46
    v_perm_b32 v94, v117, v113, s47
    v_perm_b32 v83, v124, v120, s46
    v_perm_b32 v87, v124, v120, s47
    v_perm_b32 v91, v125, v121, s46
    v_perm_b32 v95, v125, v121, s47
    v_perm_b32 v96, v102, v98, s46
    v_perm_b32 v100, v102, v98, s47
    v_perm_b32 v104, v103, v99, s46
    v_perm_b32 v108, v103, v99, s47
    v_perm_b32 v97, v110, v106, s46
    v_perm_b32 v101, v110, v106, s47
    v_perm_b32 v105, v111, v107, s46
    v_perm_b32 v109, v111, v107, s47
    v_perm_b32 v98, v118, v114, s46
    v_perm_b32 v102, v118, v114, s47
    v_perm_b32 v106, v119, v115, s46
    v_perm_b32 v110, v119, v115, s47
    v_perm_b32 v99, v126, v122, s46
    v_perm_b32 v103, v126, v122, s47
    v_perm_b32 v107, v127, v123, s46
    v_perm_b32 v111, v127, v123, s47
K_np:
    s_waitcnt lgkmcnt(0)
    s_barrier
    ds_read2st64_b32 v[16:17], v33 offset0:0 offset1:1
    ds_read2st64_b32 v[18:19], v33 offset0:2 offset1:3
    ds_read2st64_b32 v[20:21], v33 offset0:4 offset1:5
    ds_read2st64_b32 v[22:23], v33 offset0:6 offset1:7
    ds_read2st64_b32 v[24:25], v33 offset0:8 offset1:9
    ds_read2st64_b32 v[26:27], v33 offset0:10 offset1:11
    s_waitcnt lgkmcnt(2)
    v_pk_add_f32 v[16:17], v[16:17], v[18:19]
    v_pk_add_f32 v[20:21], v[20:21], v[22:23]
    v_pk_add_f32 v[16:17], v[16:17], v[20:21]
    s_waitcnt lgkmcnt(0)
    v_fma_f32 v24, -v26, v25, v24
    v_add_f32 v40, v16, v17
    v_add_f32 v40, v40, v24
    v_mul_f32 v40, v40, v27
    v_cvt_pk_bf16_f32 v40, v40, v40
    v_lshlrev_b32 v40, 16, v40
    v_add_f32 v40, v40, v145
    v_cvt_pk_bf16_f32 v40, v40, v40
    v_lshlrev_b32 v40, 16, v40
    v_max_f32 v40, 0, v40
    v_mul_f32 v40, v40, v40
    s_nop 1
    v_mov_b32_dpp v60, v40 quad_perm:[1,1,3,3] row_mask:0xf bank_mask:0xf
    v_cvt_pk_bf16_f32 v10, v40, v60
    s_nop 1
    v_mov_b32_dpp v11, v10 row_shl:2 row_mask:0xf bank_mask:0xf
    v_mov_b32_dpp v12, v10 row_shl:4 row_mask:0xf bank_mask:0xf
    v_mov_b32_dpp v13, v10 row_shl:6 row_mask:0xf bank_mask:0xf
    s_nop 1
    v_mfma_f32_16x16x32_bf16 v[14:17], v[10:13], v[80:83], 0
    v_mfma_f32_16x16x32_bf16 v[46:49], v[10:13], v[96:99], 0
    v_mfma_f32_16x16x32_bf16 v[18:21], v[10:13], v[84:87], 0
    v_mfma_f32_16x16x32_bf16 v[50:53], v[10:13], v[100:103], 0
    v_mfma_f32_16x16x32_bf16 v[22:25], v[10:13], v[88:91], 0
    v_permlane32_swap_b32 v14, v46
    v_mfma_f32_16x16x32_bf16 v[54:57], v[10:13], v[104:107], 0
    s_nop 0
    v_add_f32_dpp v2, v46, v14 row_ror:8 row_mask:0xf bank_mask:0x3
    v_mfma_f32_16x16x32_bf16 v[14:17], v[10:13], v[92:95], 0
    v_permlane32_swap_b32 v18, v50
    v_mfma_f32_16x16x32_bf16 v[46:49], v[10:13], v[108:111], 0
    s_nop 0
    v_add_f32_dpp v2, v18, v50 row_ror:8 row_mask:0xf bank_mask:0xc
    v_permlane32_swap_b32 v22, v54
    s_nop 1
    v_add_f32_dpp v3, v54, v22 row_ror:8 row_mask:0xf bank_mask:0x3
    s_nop 1
    v_permlane32_swap_b32 v14, v46
    s_nop 1
    v_add_f32_dpp v3, v14, v46 row_ror:8 row_mask:0xf bank_mask:0xc
    s_nop 1
    v_permlane16_swap_b32 v2, v3
    v_mul_f32 v59, 0x43800000, v2
    v_floor_f32 v9, v59
    v_sub_f32 v59, v59, v9
    v_cvt_i32_f32 v9, v9
    v_mul_f32 v59, 0x4f800000, v59
    v_cvt_u32_f32 v8, v59
    v_and_b32 v8, 0xfffffe00, v8
    v_or_b32 v8, 1, v8
    buffer_atomic_add_x2 v[8:9], v148, s[20:23], s48 offen
    s_lshl_b32 s33, s26, 3
    s_and_b32 s34, s26, 7
    s_add_u32 s33, s33, s34
    s_cmp_lg_u32 s33, s51
    s_cbranch_scc1 K_fin
    s_mov_b32 s39, 0
    s_sleep 16
    buffer_load_dwordx4 v[128:131], v150, s[20:23], s40 offen sc0 sc1
    buffer_load_dwordx4 v[132:135], v150, s[20:23], s41 offen sc0 sc1
    buffer_load_dwordx4 v[136:139], v150, s[20:23], s42 offen sc0 sc1
    buffer_load_dwordx4 v[140:143], v150, s[20:23], s43 offen sc0 sc1
    s_sleep 4
    buffer_load_dwordx4 v[64:67], v150, s[20:23], s40 offen sc0 sc1
    buffer_load_dwordx4 v[68:71], v150, s[20:23], s41 offen sc0 sc1
    buffer_load_dwordx4 v[72:75], v150, s[20:23], s42 offen sc0 sc1
    buffer_load_dwordx4 v[76:79], v150, s[20:23], s43 offen sc0 sc1
    s_sleep 4
    buffer_load_dwordx4 v[80:83], v150, s[20:23], s40 offen sc0 sc1
    buffer_load_dwordx4 v[84:87], v150, s[20:23], s41 offen sc0 sc1
    buffer_load_dwordx4 v[88:91], v150, s[20:23], s42 offen sc0 sc1
    buffer_load_dwordx4 v[92:95], v150, s[20:23], s43 offen sc0 sc1
K_cp2:
    s_waitcnt vmcnt(8)
    v_lshl_add_u64 v[128:129], v[128:129], 0, v[132:133]
    v_lshl_add_u64 v[130:131], v[130:131], 0, v[134:135]
    v_lshl_add_u64 v[136:137], v[136:137], 0, v[140:141]
    v_lshl_add_u64 v[138:139], v[138:139], 0, v[142:143]
    v_lshl_add_u64 v[128:129], v[128:129], 0, v[136:137]
    v_lshl_add_u64 v[130:131], v[130:131], 0, v[138:139]
    s_nop 1
    v_permlane32_swap_b32 v128, v130
    v_permlane32_swap_b32 v129, v131
    s_nop 0
    v_lshl_add_u64 v[52:53], v[128:129], 0, v[130:131]
    v_and_b32 v54, 0x1ff, v52
    v_cmp_eq_u32 vcc, 72, v54
    v_cvt_f32_u32 v52, v52
    v_cvt_f32_i32 v53, v53
    v_mul_f32 v44, 0x2b800000, v52
    v_fmac_f32 v44, 0x3b800000, v53
    s_nop 0
    s_cmp_eq_u64 vcc, exec
    s_cbranch_scc1 K_cp2_d
    buffer_load_dwordx4 v[128:131], v150, s[20:23], s40 offen sc0 sc1
    buffer_load_dwordx4 v[132:135], v150, s[20:23], s41 offen sc0 sc1
    buffer_load_dwordx4 v[136:139], v150, s[20:23], s42 offen sc0 sc1
    buffer_load_dwordx4 v[140:143], v150, s[20:23], s43 offen sc0 sc1
    s_waitcnt vmcnt(8)
    v_lshl_add_u64 v[64:65], v[64:65], 0, v[68:69]
    v_lshl_add_u64 v[66:67], v[66:67], 0, v[70:71]
    v_lshl_add_u64 v[72:73], v[72:73], 0, v[76:77]
    v_lshl_add_u64 v[74:75], v[74:75], 0, v[78:79]
    v_lshl_add_u64 v[64:65], v[64:65], 0, v[72:73]
    v_lshl_add_u64 v[66:67], v[66:67], 0, v[74:75]
    s_nop 1
    v_permlane32_swap_b32 v64, v66
    v_permlane32_swap_b32 v65, v67
    s_nop 0
    v_lshl_add_u64 v[52:53], v[64:65], 0, v[66:67]
    v_and_b32 v54, 0x1ff, v52
    v_cmp_eq_u32 vcc, 72, v54
    v_cvt_f32_u32 v52, v52
    v_cvt_f32_i32 v53, v53
    v_mul_f32 v44, 0x2b800000, v52
    v_fmac_f32 v44, 0x3b800000, v53
    s_nop 0
    s_cmp_eq_u64 vcc, exec
    s_cbranch_scc1 K_cp2_d
    buffer_load_dwordx4 v[64:67], v150, s[20:23], s40 offen sc0 sc1
    buffer_load_dwordx4 v[68:71], v150, s[20:23], s41 offen sc0 sc1
    buffer_load_dwordx4 v[72:75], v150, s[20:23], s42 offen sc0 sc1
    buffer_load_dwordx4 v[76:79], v150, s[20:23], s43 offen sc0 sc1
    s_waitcnt vmcnt(8)
    v_lshl_add_u64 v[80:81], v[80:81], 0, v[84:85]
    v_lshl_add_u64 v[82:83], v[82:83], 0, v[86:87]
    v_lshl_add_u64 v[88:89], v[88:89], 0, v[92:93]
    v_lshl_add_u64 v[90:91], v[90:91], 0, v[94:95]
    v_lshl_add_u64 v[80:81], v[80:81], 0, v[88:89]
    v_lshl_add_u64 v[82:83], v[82:83], 0, v[90:91]
    s_nop 1
    v_permlane32_swap_b32 v80, v82
    v_permlane32_swap_b32 v81, v83
    s_nop 0
    v_lshl_add_u64 v[52:53], v[80:81], 0, v[82:83]
    v_and_b32 v54, 0x1ff, v52
    v_cmp_eq_u32 vcc, 72, v54
    v_cvt_f32_u32 v52, v52
    v_cvt_f32_i32 v53, v53
    v_mul_f32 v44, 0x2b800000, v52
    v_fmac_f32 v44, 0x3b800000, v53
    s_nop 0
    s_cmp_eq_u64 vcc, exec
    s_cbranch_scc1 K_cp2_d
    buffer_load_dwordx4 v[80:83], v150, s[20:23], s40 offen sc0 sc1
    buffer_load_dwordx4 v[84:87], v150, s[20:23], s41 offen sc0 sc1
    buffer_load_dwordx4 v[88:91], v150, s[20:23], s42 offen sc0 sc1
    buffer_load_dwordx4 v[92:95], v150, s[20:23], s43 offen sc0 sc1
    s_add_u32 s39, s39, 1
    s_cmp_lt_u32 s39, 2097152
    s_cbranch_scc1 K_cp2
    s_waitcnt vmcnt(0)
K_cp2_f0:
    s_branch K_cp2_d
K_cp2_f1:
    s_branch K_cp2_d
K_cp2_f2:
K_cp2_d:
    v_cvt_pk_bf16_f32 v44, v44, v44
    v_lshlrev_b32 v44, 16, v44
    v_add_f32 v44, v44, v146
    v_cvt_pk_bf16_f32 v44, v44, v44
    v_lshlrev_b32 v44, 16, v44
    v_add_f32 v44, v44, v147
    v_cvt_pk_bf16_f32 v44, v44, v44
    buffer_store_short v44, v37, s[96:99], 0 offen
K_fin:
K_end:
    s_endpgm
.section .rodata,"a"
.p2align 6
.amdhsa_kernel fused_kernel
  .amdhsa_next_free_vgpr 168
  .amdhsa_next_free_sgpr 102
  .amdhsa_accum_offset 168
  .amdhsa_group_segment_fixed_size 0
  .amdhsa_kernarg_size 104
  .amdhsa_user_sgpr_count 2
  .amdhsa_user_sgpr_kernarg_segment_ptr 1
  .amdhsa_system_sgpr_workgroup_id_x 1
.end_amdhsa_kernel
```
